```python
import torch

def _softmax(x, axis=-1):
    return torch.softmax(x, dim=axis)
def _gelu(x):
    return torch.nn.functional.gelu(x, approximate="tanh")
def _silu(x):
    return torch.nn.functional.silu(x)
def _sigmoid(x):
    return torch.sigmoid(x)
def _layernorm(x, axis=-1, eps=1e-5):
    m = x.mean(dim=axis, keepdim=True)
    v = x.var(dim=axis, keepdim=True, unbiased=False)
    return (x - m) / torch.sqrt(v + eps)
def _scatter_add(tgt, idx, src, axis=0):
    return tgt.clone().index_add_(axis, idx, src)
def _segment_sum(src, seg, n):
    out = torch.zeros((n,) + src.shape[1:], dtype=src.dtype)
    return out.index_add_(0, seg, src)
def _pad(x, pw):
    flat = tuple(v for pair in reversed(pw) for v in pair)
    return torch.nn.functional.pad(x, flat)

kernel_name = 'parallel_sum__ssm_conv_s4__dense_activation_relu__prompt'

def setup_inputs():

    _w = (lambda a: (lambda t: t.to(torch.bfloat16) if t.is_floating_point() else t)(torch.as_tensor(a)))
    def _A_setup():
        B, L, D, N = 1, 2048, 512, 128
        A_re = -(lambda _x: torch.exp(torch.as_tensor(_x)))((lambda *s: torch.randn(*s, dtype=torch.bfloat16) * 3.2)(D, N))
        A_im = torch.pi * (lambda *s: torch.randn(*s, dtype=torch.bfloat16) * 0.2)(D, N)
        B_re = (lambda *s: torch.randn(*s, dtype=torch.bfloat16) * 0.4)(D, N)
        B_im = (lambda *s: torch.randn(*s, dtype=torch.bfloat16) * 0.4)(D, N)
        C_re = (lambda *s: torch.randn(*s, dtype=torch.bfloat16) * 0.4)(D, N)
        C_im = (lambda *s: torch.randn(*s, dtype=torch.bfloat16) * 0.4)(D, N)
        log_dt = (lambda *s: torch.randn(*s, dtype=torch.bfloat16) * 0.2)(D) * 0.5 - 4.0
        Dskip = (lambda *s: torch.randn(*s, dtype=torch.bfloat16) * 0.4)(D)
        return {
            "u": _w((lambda *s: torch.randn(*s, dtype=torch.bfloat16) * 0.05)(B, L, D)),
            "A_re": _w(A_re),
            "A_im": _w(A_im),
            "B_re": _w(B_re),
            "B_im": _w(B_im),
            "C_re": _w(C_re),
            "C_im": _w(C_im),
            "log_dt": _w(log_dt),
            "Dskip": _w(Dskip),
        }
    _A_in = _A_setup()

    def _B_setup():
        B, S, D, Dff = 1, 2048, 512, 1792
        return {
            "x": _w((lambda *s: torch.randn(*s, dtype=torch.bfloat16) * 0.05)(B, S, D)),
            "w1": _w((lambda *s: torch.randn(*s, dtype=torch.bfloat16) * 0.05)(D, Dff)),
            "w2": _w((lambda *s: torch.randn(*s, dtype=torch.bfloat16) * 0.05)(Dff, D)),
        }
    _B_in = _B_setup()

    return {
        "A_u": _A_in["u"],
        "A_A_re": _A_in["A_re"],
        "A_A_im": _A_in["A_im"],
        "A_B_re": _A_in["B_re"],
        "A_B_im": _A_in["B_im"],
        "A_C_re": _A_in["C_re"],
        "A_C_im": _A_in["C_im"],
        "A_log_dt": _A_in["log_dt"],
        "A_Dskip": _A_in["Dskip"],
        "B_x": _B_in["x"],
        "B_w1": _B_in["w1"],
        "B_w2": _B_in["w2"],
    }

def reference(A_u, A_A_re, A_A_im, A_B_re, A_B_im, A_C_re, A_C_im, A_log_dt, A_Dskip, B_x, B_w1, B_w2):
    def _A_ref(u, A_re, A_im, B_re, B_im, C_re, C_im, log_dt, Dskip):
        Bsz, L, D = u.shape
        dt = torch.exp(log_dt)[:, None]
        A = A_re + 1j * A_im
        Bc = B_re + 1j * B_im
        Cc = C_re + 1j * C_im
        logdA = dt * A
        dB = dt * Bc
        l = (lambda x, dt: x.to(dt))(torch.arange(L), A_re.dtype)
        P = torch.exp(logdA[:, :, None] * l[None, None, :])
        K = torch.einsum("dn,dnl,dn->dl", Cc, P, dB).real
        L2 = 2 * L
        Kp = _pad(K, ((0, 0), (0, L)))
        up = (lambda x, *d: x.permute(*d))(u, 0, 2, 1)
        up = _pad(up, ((0, 0), (0, 0), (0, L)))
        Kf = (lambda x, axes=(-2,-1): torch.fft.rfft2(x.float(), dim=axes))(Kp[:, None, :], axes=(-2, -1))
        Uf = (lambda x, axes=(-2,-1): torch.fft.rfft2(x.float(), dim=axes))(up[:, :, None, :], axes=(-2, -1))
        Yf = Uf * Kf[None, :, :, :]
        y = (lambda x, s, axes=(-2,-1): torch.fft.irfft2(x, s=s, dim=axes).to(torch.bfloat16))(Yf, (1, L2), axes=(-2, -1))[:, :, 0, :L]
        y = (lambda x, *d: x.permute(*d))(y, 0, 2, 1) + u * Dskip[None, None, :]
        return y

    def _B_ref(x, w1, w2):
        h = torch.einsum("bsd,df->bsf", x, w1)
        zero = torch.zeros_like(h)
        h = torch.maximum(h, zero)
        return torch.einsum("bsf,fd->bsd", h, w2)

    x = A_u
    xn = _layernorm(x, axis=-1)
    return x + _A_ref(xn, A_A_re, A_A_im, A_B_re, A_B_im, A_C_re, A_C_im, A_log_dt, A_Dskip) + _B_ref(xn, B_w1, B_w2)
```

```asm
; @launch grid=(256,1,1) block=(512,1,1) lds=163840
.amdgcn_target "amdgcn-amd-amdhsa--gfx950"
.text
.globl parallel_sum__ssm_conv_s4__dense_activation_relu__prompt_kernel
.p2align 8
.type parallel_sum__ssm_conv_s4__dense_activation_relu__prompt_kernel,@function
parallel_sum__ssm_conv_s4__dense_activation_relu__prompt_kernel:
    s_cmp_ge_u32 s2, 256
    s_cbranch_scc1 L_END
    s_load_dwordx16 s[4:19], s[0:1], 0
    s_load_dwordx8 s[20:27], s[0:1], 64
    s_load_dwordx4 s[28:31], s[0:1], 96
    s_load_dwordx2 s[32:33], s[0:1], 112
    s_getpc_b64 s[40:41]
L_PCREF:
    s_lshr_b32 s3, s2, 3
    s_mul_i32 s3, s3, (L_CODE_END - parallel_sum__ssm_conv_s4__dense_activation_relu__prompt_kernel + 4095) / 4096
    v_subrev_u32 v2, 0, v0
    v_cmp_gt_u32 vcc, (L_CODE_END - parallel_sum__ssm_conv_s4__dense_activation_relu__prompt_kernel + 4095) / 4096, v2
    v_add_lshl_u32 v2, v2, s3, 7
    s_sub_u32 s40, s40, L_PCREF - parallel_sum__ssm_conv_s4__dense_activation_relu__prompt_kernel
    s_subb_u32 s41, s41, 0
    s_mov_b32 s42, L_CODE_END - parallel_sum__ssm_conv_s4__dense_activation_relu__prompt_kernel
    s_mov_b32 s43, 0x20000
    v_cndmask_b32 v2, -1, v2, vcc
    buffer_load_dword v63, v2, s[40:43], 0 offen
    v_lshrrev_b32 v2, 6, v0
    v_and_b32 v9, 255, v0
    s_lshl_b32 s73, s2, 9
    v_readfirstlane_b32 s60, v2
    v_lshl_add_u32 v9, v9, 1, s73
    v_and_b32 v1, 63, v0
    v_mov_b32 v56, 0
    v_mov_b32 v57, 0
    v_mov_b32 v58, 0
    v_mov_b32 v59, 0
    v_mov_b32 v60, 0
    v_mov_b32 v61, 0
    s_lshl_b32 s77, s2, 2
    s_bfe_u32 s76, s2, 0x20001
    s_and_b32 s63, s2, 1
    s_lshr_b32 s75, s2, 6
    s_bfe_u32 s67, s2, 0x30003
    s_lshl2_add_u32 s61, s76, s75
    s_mul_i32 s62, s63, 7
    s_add_u32 s62, s62, s67
    s_add_u32 s74, s75, s67
    s_and_b32 s74, s74, 1
    s_lshl1_add_u32 s64, s63, s76
    s_lshl2_add_u32 s64, s74, s64
    s_and_b32 s64, s64, 7
    s_and_b32 s66, s2, 7
    s_lshl2_add_u32 s66, s66, s75
    s_and_b32 s76, s67, 3
    s_cmp_eq_u32 s76, 3
    s_cselect_b32 s76, 4, 0
    s_xor_b32 s67, s67, s76
    s_lshl_b32 s68, s61, 17
    s_lshl_b32 s69, s62, 8
    s_lshl_b32 s73, s64, 7
    s_add_u32 s73, s73, s68
    s_mul_i32 s74, s64, 229376
    s_add_u32 s74, s74, s69
    s_add_u32 s64, s64, 1
    s_and_b32 s64, s64, 7
    v_lshrrev_b32 v2, 3, v1
    v_lshrrev_b32 v3, 4, v1
    v_and_b32 v4, 7, v1
    s_lshl_b32 s75, s60, 15
    v_lshl_add_u32 v5, v2, 10, s75
    v_bfe_u32 v6, v1, 4, 1
    v_lshlrev_b32 v6, 2, v6
    v_xor_b32 v6, v4, v6
    v_lshl_add_u32 v24, v6, 4, v5
    v_add_u32 v25, 7152, v24
    v_add_u32 v26, 14304, v24
    v_add_u32 v27, 21456, v24
    s_lshl_b32 s75, s60, 4
    v_add_u32 v5, s75, v3
    v_mul_u32_u24 v5, 3584, v5
    v_and_b32 v6, 15, v1
    v_lshlrev_b32 v7, 2, v3
    v_xor_b32 v6, v6, v7
    v_lshl_add_u32 v28, v6, 4, v5
    v_add_u32 v29, 13312, v28
    v_add_u32 v30, 26624, v28
    v_add_u32 v31, 39936, v28
    s_cmp_lt_u32 s60, 4
    s_cbranch_scc1 L_NOPRIO
    s_setprio 3
L_NOPRIO:
    s_waitcnt lgkmcnt(0)
    s_cmp_lt_u32 s60, 4
    s_cbranch_scc1 L_FWAVE
    global_load_short_d16_hi v56, v9, s[6:7]
    global_load_short_d16_hi v57, v9, s[8:9]
    global_load_short_d16_hi v58, v9, s[10:11]
    global_load_short_d16_hi v59, v9, s[12:13]
    global_load_short_d16_hi v60, v9, s[14:15]
    global_load_short_d16_hi v61, v9, s[16:17]
    s_load_dword s70, s[18:19], s77
    s_load_dword s71, s[20:21], s77
    s_branch L_SWAVE
L_FWAVE:
    s_setprio 1
    s_mov_b32 s36, s4
    s_mov_b32 s37, s5
    s_mov_b32 s38, 0x200000
    s_mov_b32 s39, 0x20000
    s_cmp_eq_u32 s67, 3
    s_cbranch_scc1 L_SPARE0
    s_mov_b32 s40, s24
    s_mov_b32 s41, s25
    s_mov_b32 s42, 0x1c0000
    s_mov_b32 s43, 0x20000
    s_mul_i32 s76, s60, 4160
    s_add_u32 m0, s76, 0
    s_nop 0
    buffer_load_dwordx4 v24, s[36:39], s73 offen offset:0 lds
    buffer_load_dwordx4 v25, s[36:39], s73 offen offset:1040 lds
    buffer_load_dwordx4 v26, s[36:39], s73 offen offset:2080 lds
    buffer_load_dwordx4 v27, s[36:39], s73 offen offset:3120 lds
    s_mul_i32 s76, s60, 4096
    s_add_u32 m0, s76, 16640
    s_nop 0
    buffer_load_dwordx4 v28, s[40:43], s74 offen offset:0 lds
    buffer_load_dwordx4 v29, s[40:43], s74 offen offset:1024 lds
    buffer_load_dwordx4 v30, s[40:43], s74 offen offset:2048 lds
    buffer_load_dwordx4 v31, s[40:43], s74 offen offset:3072 lds
    s_lshl_b32 s73, s64, 7
    s_add_u32 s73, s73, s68
    s_mul_i32 s74, s64, 229376
    s_add_u32 s74, s74, s69
    s_add_u32 s64, s64, 1
    s_and_b32 s64, s64, 7
    s_mov_b32 s3, s73
    s_mov_b32 s72, s74
    s_mul_i32 s22, s60, 4160
    s_add_u32 s22, s22, 33024
    s_lshl_b32 s23, s60, 12
    s_add_u32 s23, s23, 49664
    s_mov_b32 s56, s30
    s_mov_b32 s57, s31
    s_mov_b32 s58, 0x100
    s_mov_b32 s59, 0x20000
    s_cmp_lg_u32 s2, 0
    s_cbranch_scc1 L_notag_1
    s_cmp_lg_u32 s60, 3
    s_cbranch_scc1 L_notag_1
    s_memrealtime s[100:101]
    s_waitcnt lgkmcnt(0)
    s_or_b32 s73, s100, 1
    v_mov_b32 v20, s73
    s_mov_b64 exec, 1
    buffer_store_dword v20, off, s[56:59], 0 sc1
    s_mov_b64 exec, -1
L_notag_1:
    s_mov_b32 s52, s32
    s_mov_b32 s53, s33
    s_mov_b32 s54, 0xb40000
    s_mov_b32 s55, 0x20000
    s_mov_b32 s44, s26
    s_mov_b32 s45, s27
    s_mov_b32 s46, 0x1c0000
    s_mov_b32 s47, 0x20000
    s_mov_b32 s48, s28
    s_mov_b32 s49, s29
    s_mov_b32 s50, 0x200000
    s_mov_b32 s51, 0x20000
    v_lshrrev_b32 v2, 3, v1
    v_and_b32 v3, 7, v1
    v_bfe_u32 v4, v1, 4, 1
    v_lshlrev_b32 v4, 2, v4
    v_xor_b32 v3, v3, v4
    v_lshlrev_b32 v3, 4, v3
    v_lshl_add_u32 v10, v2, 10, v3
    v_add_u32 v11, 7168, v10
    v_add_u32 v12, 14336, v10
    v_add_u32 v13, 21504, v10
    s_mul_i32 s76, s60, 28
    s_lshl_b32 s9, s76, 14
    s_lshl_b32 s78, s67, 7
    s_add_u32 s9, s9, s78
    s_mul_i32 s10, s66, 224
    s_add_u32 s10, s10, s76
    s_lshl_b32 s10, s10, 10
    v_bfe_u32 v2, v1, 2, 2
    v_lshrrev_b32 v3, 5, v1
    v_lshl_add_u32 v3, v3, 2, v2
    v_lshlrev_b32 v3, 7, v3
    v_lshrrev_b32 v2, 1, v2
    v_lshl_add_u32 v3, v2, 6, v3
    v_bfe_u32 v2, v1, 4, 1
    v_lshl_add_u32 v3, v2, 5, v3
    v_and_b32 v2, 3, v1
    v_lshl_add_u32 v3, v2, 3, v3
    s_lshl_b32 s76, s60, 13
    v_add_u32 v14, s76, v3
    v_xor_b32 v15, 64, v14
    v_add_u32 v16, 66048, v14
    v_add_u32 v17, 66048, v15
    v_lshlrev_b32 v18, 4, v1
    v_add_u32 v19, 114688, v18
    v_lshrrev_b32 v3, 5, v1
    v_bfe_u32 v2, v1, 3, 2
    v_mul_u32_u24 v2, 1040, v2
    v_and_b32 v4, 7, v1
    v_lshl_add_u32 v2, v4, 7, v2
    v_lshl_add_u32 v2, v3, 4, v2
    s_and_b32 s76, s60, 1
    s_mul_i32 s76, s76, 8320
    s_lshr_b32 s75, s60, 1
    s_mul_i32 s75, s75, 4160
    s_add_u32 s100, s76, s75
    s_sub_u32 s101, s76, s75
    s_add_u32 s101, s101, 4160
    v_bfe_u32 v4, v1, 1, 1
    v_lshlrev_b32 v4, 6, v4
    v_xor_b32 v5, 64, v4
    v_add3_u32 v32, v2, v4, s100
    v_add3_u32 v33, v2, v5, s100
    v_add_u32 v34, 66048, v32
    v_add_u32 v35, 66048, v33
    v_add3_u32 v36, v2, v4, s101
    v_add3_u32 v37, v2, v5, s101
    v_add_u32 v38, 66048, v36
    v_add_u32 v39, 66048, v37
    v_bfe_u32 v2, v1, 2, 2
    v_lshl_add_u32 v5, v3, 3, v2
    v_lshlrev_b32 v5, 8, v5
    v_xor_b32 v2, s60, v2
    v_lshl_add_u32 v5, v2, 6, v5
    v_bfe_u32 v2, v1, 4, 1
    v_lshl_add_u32 v5, v2, 5, v5
    v_and_b32 v2, 3, v1
    v_lshl_add_u32 v5, v2, 3, v5
    v_add_u32 v40, 16640, v5
    v_xor_b32 v5, 64, v5
    v_add_u32 v42, 16640, v5
    v_add_u32 v41, 66048, v40
    v_add_u32 v43, 66048, v42
    v_lshrrev_b32 v2, 4, v1
    v_xor_b32 v2, v2, v1
    v_and_b32 v2, 1, v2
    v_subrev_u32 v2, 1, v2
    v_and_b32 v52, 0x3f803f80, v2
    v_and_b32 v53, 0x3f803f80, v2
    v_and_b32 v54, 0x3f803f80, v2
    v_and_b32 v55, 0x3f803f80, v2
    s_waitcnt lgkmcnt(0)
    s_mov_b32 m0, s22
    s_nop 0
    buffer_load_dwordx4 v24, s[36:39], s3 offen offset:0 lds
    buffer_load_dwordx4 v25, s[36:39], s3 offen offset:1040 lds
    buffer_load_dwordx4 v26, s[36:39], s3 offen offset:2080 lds
    buffer_load_dwordx4 v27, s[36:39], s3 offen offset:3120 lds
    s_mov_b32 m0, s23
    s_nop 0
    buffer_load_dwordx4 v28, s[40:43], s72 offen offset:0 lds
    buffer_load_dwordx4 v29, s[40:43], s72 offen offset:1024 lds
    buffer_load_dwordx4 v30, s[40:43], s72 offen offset:2048 lds
    buffer_load_dwordx4 v31, s[40:43], s72 offen offset:3072 lds
    s_waitcnt lgkmcnt(0)
    s_waitcnt vmcnt(8)
    s_barrier
    ds_read_b128 v[128:131], v32 offset:0
    ds_read_b64_tr_b16 v[136:137], v40 offset:0
    ds_read_b64_tr_b16 v[138:139], v40 offset:1024
    ds_read_b128 v[132:135], v36 offset:0
    ds_read_b64_tr_b16 v[140:141], v42 offset:0
    ds_read_b64_tr_b16 v[142:143], v42 offset:1024
    s_lshl_b32 s73, s64, 7
    s_add_u32 s73, s73, s68
    s_mul_i32 s74, s64, 229376
    s_add_u32 s74, s74, s69
    s_add_u32 s64, s64, 1
    s_and_b32 s64, s64, 7
    s_waitcnt lgkmcnt(3)
    v_mfma_f32_32x32x16_bf16 v[64:79], v[136:139], v[128:131], 0
    ds_read_b128 v[144:147], v32 offset:32
    ds_read_b64_tr_b16 v[152:153], v40 offset:4096
    v_mfma_f32_16x16x32_bf16 v[44:47], v[52:55], v[128:131], 0
    s_mul_i32 s76, s60, 4160
    s_add_u32 m0, s76, 66048
    s_nop 0
    buffer_load_dwordx4 v24, s[36:39], s73 offen offset:0 lds
    s_waitcnt lgkmcnt(4)
    v_mfma_f32_32x32x16_bf16 v[80:95], v[136:139], v[132:135], 0
    ds_read_b64_tr_b16 v[154:155], v40 offset:5120
    ds_read_b128 v[148:151], v36 offset:32
    buffer_load_dwordx4 v25, s[36:39], s73 offen offset:1040 lds
    s_waitcnt lgkmcnt(4)
    v_mfma_f32_32x32x16_bf16 v[96:111], v[140:143], v[128:131], 0
    ds_read_b64_tr_b16 v[156:157], v42 offset:4096
    ds_read_b64_tr_b16 v[158:159], v42 offset:5120
    v_mfma_f32_16x16x32_bf16 v[48:51], v[52:55], v[136:139], 0
    buffer_load_dwordx4 v26, s[36:39], s73 offen offset:2080 lds
    v_mfma_f32_32x32x16_bf16 v[112:127], v[140:143], v[132:135], 0
    s_waitcnt lgkmcnt(3)
    v_mfma_f32_32x32x16_bf16 v[64:79], v[152:155], v[144:147], v[64:79]
    ds_read_b128 v[128:131], v33 offset:0
    ds_read_b64_tr_b16 v[136:137], v40 offset:8192
    v_mfma_f32_16x16x32_bf16 v[44:47], v[52:55], v[144:147], v[44:47]
    buffer_load_dwordx4 v27, s[36:39], s73 offen offset:3120 lds
    s_waitcnt lgkmcnt(4)
    v_mfma_f32_32x32x16_bf16 v[80:95], v[152:155], v[148:151], v[80:95]
    ds_read_b64_tr_b16 v[138:139], v40 offset:9216
    ds_read_b128 v[132:135], v37 offset:0
    s_mul_i32 s76, s60, 4096
    s_add_u32 m0, s76, 82688
    s_nop 0
    buffer_load_dwordx4 v28, s[40:43], s74 offen offset:0 lds
    s_waitcnt lgkmcnt(4)
    v_mfma_f32_32x32x16_bf16 v[96:111], v[156:159], v[144:147], v[96:111]
    ds_read_b64_tr_b16 v[140:141], v42 offset:8192
    ds_read_b64_tr_b16 v[142:143], v42 offset:9216
    v_mfma_f32_16x16x32_bf16 v[48:51], v[52:55], v[152:155], v[48:51]
    buffer_load_dwordx4 v29, s[40:43], s74 offen offset:1024 lds
    v_mfma_f32_32x32x16_bf16 v[112:127], v[156:159], v[148:151], v[112:127]
    s_waitcnt lgkmcnt(3)
    v_mfma_f32_32x32x16_bf16 v[64:79], v[136:139], v[128:131], v[64:79]
    ds_read_b128 v[144:147], v33 offset:32
    ds_read_b64_tr_b16 v[152:153], v40 offset:12288
    ds_read_b64_tr_b16 v[154:155], v40 offset:13312
    v_mfma_f32_16x16x32_bf16 v[44:47], v[52:55], v[128:131], v[44:47]
    buffer_load_dwordx4 v30, s[40:43], s74 offen offset:2048 lds
    s_waitcnt lgkmcnt(5)
    v_mfma_f32_32x32x16_bf16 v[80:95], v[136:139], v[132:135], v[80:95]
    ds_read_b128 v[148:151], v37 offset:32
    ds_read_b64_tr_b16 v[156:157], v42 offset:12288
    ds_read_b64_tr_b16 v[158:159], v42 offset:13312
    buffer_load_dwordx4 v31, s[40:43], s74 offen offset:3072 lds
    s_waitcnt lgkmcnt(6)
    v_mfma_f32_32x32x16_bf16 v[96:111], v[140:143], v[128:131], v[96:111]
    v_mfma_f32_16x16x32_bf16 v[48:51], v[52:55], v[136:139], v[48:51]
    v_mfma_f32_32x32x16_bf16 v[112:127], v[140:143], v[132:135], v[112:127]
    s_waitcnt lgkmcnt(0)
    s_waitcnt vmcnt(8)
    s_barrier
    v_mfma_f32_32x32x16_bf16 v[64:79], v[152:155], v[144:147], v[64:79]
    ds_read_b128 v[128:131], v32 offset:33024
    ds_read_b64_tr_b16 v[136:137], v40 offset:33024
    v_mfma_f32_16x16x32_bf16 v[44:47], v[52:55], v[144:147], v[44:47]
    v_mfma_f32_32x32x16_bf16 v[80:95], v[152:155], v[148:151], v[80:95]
    ds_read_b64_tr_b16 v[138:139], v40 offset:34048
    ds_read_b128 v[132:135], v36 offset:33024
    v_mfma_f32_32x32x16_bf16 v[96:111], v[156:159], v[144:147], v[96:111]
    ds_read_b64_tr_b16 v[140:141], v42 offset:33024
    ds_read_b64_tr_b16 v[142:143], v42 offset:34048
    v_mfma_f32_16x16x32_bf16 v[48:51], v[52:55], v[152:155], v[48:51]
    v_mfma_f32_32x32x16_bf16 v[112:127], v[156:159], v[148:151], v[112:127]
    s_lshl_b32 s73, s64, 7
    s_add_u32 s73, s73, s68
    s_mul_i32 s74, s64, 229376
    s_add_u32 s74, s74, s69
    s_add_u32 s64, s64, 1
    s_and_b32 s64, s64, 7
    buffer_load_dword v20, off, s[56:59], 0 sc1
    s_waitcnt lgkmcnt(3)
    v_mfma_f32_32x32x16_bf16 v[64:79], v[136:139], v[128:131], v[64:79]
    ds_read_b128 v[144:147], v32 offset:33056
    ds_read_b64_tr_b16 v[152:153], v40 offset:37120
    v_mfma_f32_16x16x32_bf16 v[44:47], v[52:55], v[128:131], v[44:47]
    s_mul_i32 s76, s60, 4160
    s_add_u32 m0, s76, 0
    s_nop 0
    buffer_load_dwordx4 v24, s[36:39], s73 offen offset:0 lds
    s_waitcnt lgkmcnt(4)
    v_mfma_f32_32x32x16_bf16 v[80:95], v[136:139], v[132:135], v[80:95]
    ds_read_b64_tr_b16 v[154:155], v40 offset:38144
    ds_read_b128 v[148:151], v36 offset:33056
    buffer_load_dwordx4 v25, s[36:39], s73 offen offset:1040 lds
    s_waitcnt lgkmcnt(4)
    v_mfma_f32_32x32x16_bf16 v[96:111], v[140:143], v[128:131], v[96:111]
    ds_read_b64_tr_b16 v[156:157], v42 offset:37120
    ds_read_b64_tr_b16 v[158:159], v42 offset:38144
    v_mfma_f32_16x16x32_bf16 v[48:51], v[52:55], v[136:139], v[48:51]
    buffer_load_dwordx4 v26, s[36:39], s73 offen offset:2080 lds
    v_mfma_f32_32x32x16_bf16 v[112:127], v[140:143], v[132:135], v[112:127]
    s_waitcnt lgkmcnt(3)
    v_mfma_f32_32x32x16_bf16 v[64:79], v[152:155], v[144:147], v[64:79]
    ds_read_b128 v[128:131], v33 offset:33024
    ds_read_b64_tr_b16 v[136:137], v40 offset:41216
    v_mfma_f32_16x16x32_bf16 v[44:47], v[52:55], v[144:147], v[44:47]
    buffer_load_dwordx4 v27, s[36:39], s73 offen offset:3120 lds
    s_waitcnt lgkmcnt(4)
    v_mfma_f32_32x32x16_bf16 v[80:95], v[152:155], v[148:151], v[80:95]
    ds_read_b64_tr_b16 v[138:139], v40 offset:42240
    ds_read_b128 v[132:135], v37 offset:33024
    s_mul_i32 s76, s60, 4096
    s_add_u32 m0, s76, 16640
    s_nop 0
    buffer_load_dwordx4 v28, s[40:43], s74 offen offset:0 lds
    s_waitcnt lgkmcnt(4)
    v_mfma_f32_32x32x16_bf16 v[96:111], v[156:159], v[144:147], v[96:111]
    ds_read_b64_tr_b16 v[140:141], v42 offset:41216
    ds_read_b64_tr_b16 v[142:143], v42 offset:42240
    v_mfma_f32_16x16x32_bf16 v[48:51], v[52:55], v[152:155], v[48:51]
    buffer_load_dwordx4 v29, s[40:43], s74 offen offset:1024 lds
    v_mfma_f32_32x32x16_bf16 v[112:127], v[156:159], v[148:151], v[112:127]
    s_waitcnt lgkmcnt(3)
    v_mfma_f32_32x32x16_bf16 v[64:79], v[136:139], v[128:131], v[64:79]
    ds_read_b128 v[144:147], v33 offset:33056
    ds_read_b64_tr_b16 v[152:153], v40 offset:45312
    ds_read_b64_tr_b16 v[154:155], v40 offset:46336
    v_mfma_f32_16x16x32_bf16 v[44:47], v[52:55], v[128:131], v[44:47]
    buffer_load_dwordx4 v30, s[40:43], s74 offen offset:2048 lds
    s_waitcnt lgkmcnt(5)
    v_mfma_f32_32x32x16_bf16 v[80:95], v[136:139], v[132:135], v[80:95]
    ds_read_b128 v[148:151], v37 offset:33056
    ds_read_b64_tr_b16 v[156:157], v42 offset:45312
    ds_read_b64_tr_b16 v[158:159], v42 offset:46336
    buffer_load_dwordx4 v31, s[40:43], s74 offen offset:3072 lds
    s_waitcnt lgkmcnt(6)
    v_mfma_f32_32x32x16_bf16 v[96:111], v[140:143], v[128:131], v[96:111]
    v_mfma_f32_16x16x32_bf16 v[48:51], v[52:55], v[136:139], v[48:51]
    v_mfma_f32_32x32x16_bf16 v[112:127], v[140:143], v[132:135], v[112:127]
    s_waitcnt lgkmcnt(0)
    s_waitcnt vmcnt(9)
    s_barrier
    v_mfma_f32_32x32x16_bf16 v[64:79], v[152:155], v[144:147], v[64:79]
    ds_read_b128 v[128:131], v34 offset:0
    ds_read_b64_tr_b16 v[136:137], v41 offset:0
    v_mfma_f32_16x16x32_bf16 v[44:47], v[52:55], v[144:147], v[44:47]
    v_mfma_f32_32x32x16_bf16 v[80:95], v[152:155], v[148:151], v[80:95]
    ds_read_b64_tr_b16 v[138:139], v41 offset:1024
    ds_read_b128 v[132:135], v38 offset:0
    v_mfma_f32_32x32x16_bf16 v[96:111], v[156:159], v[144:147], v[96:111]
    ds_read_b64_tr_b16 v[140:141], v43 offset:0
    ds_read_b64_tr_b16 v[142:143], v43 offset:1024
    v_mfma_f32_16x16x32_bf16 v[48:51], v[52:55], v[152:155], v[48:51]
    v_mfma_f32_32x32x16_bf16 v[112:127], v[156:159], v[148:151], v[112:127]
    s_lshl_b32 s73, s64, 7
    s_add_u32 s73, s73, s68
    s_mul_i32 s74, s64, 229376
    s_add_u32 s74, s74, s69
    s_add_u32 s64, s64, 1
    s_and_b32 s64, s64, 7
    s_waitcnt lgkmcnt(3)
    v_mfma_f32_32x32x16_bf16 v[64:79], v[136:139], v[128:131], v[64:79]
    ds_read_b128 v[144:147], v34 offset:32
    ds_read_b64_tr_b16 v[152:153], v41 offset:4096
    v_mfma_f32_16x16x32_bf16 v[44:47], v[52:55], v[128:131], v[44:47]
    s_mul_i32 s76, s60, 4160
    s_add_u32 m0, s76, 33024
    s_nop 0
    buffer_load_dwordx4 v24, s[36:39], s73 offen offset:0 lds
    s_waitcnt lgkmcnt(4)
    v_mfma_f32_32x32x16_bf16 v[80:95], v[136:139], v[132:135], v[80:95]
    ds_read_b64_tr_b16 v[154:155], v41 offset:5120
    ds_read_b128 v[148:151], v38 offset:32
    buffer_load_dwordx4 v25, s[36:39], s73 offen offset:1040 lds
    s_waitcnt lgkmcnt(4)
    v_mfma_f32_32x32x16_bf16 v[96:111], v[140:143], v[128:131], v[96:111]
    ds_read_b64_tr_b16 v[156:157], v43 offset:4096
    ds_read_b64_tr_b16 v[158:159], v43 offset:5120
    v_mfma_f32_16x16x32_bf16 v[48:51], v[52:55], v[136:139], v[48:51]
    buffer_load_dwordx4 v26, s[36:39], s73 offen offset:2080 lds
    v_mfma_f32_32x32x16_bf16 v[112:127], v[140:143], v[132:135], v[112:127]
    s_waitcnt lgkmcnt(3)
    v_mfma_f32_32x32x16_bf16 v[64:79], v[152:155], v[144:147], v[64:79]
    ds_read_b128 v[128:131], v35 offset:0
    ds_read_b64_tr_b16 v[136:137], v41 offset:8192
    v_mfma_f32_16x16x32_bf16 v[44:47], v[52:55], v[144:147], v[44:47]
    buffer_load_dwordx4 v27, s[36:39], s73 offen offset:3120 lds
    s_waitcnt lgkmcnt(4)
    v_mfma_f32_32x32x16_bf16 v[80:95], v[152:155], v[148:151], v[80:95]
    ds_read_b64_tr_b16 v[138:139], v41 offset:9216
    ds_read_b128 v[132:135], v39 offset:0
    s_mul_i32 s76, s60, 4096
    s_add_u32 m0, s76, 49664
    s_nop 0
    buffer_load_dwordx4 v28, s[40:43], s74 offen offset:0 lds
    s_waitcnt lgkmcnt(4)
    v_mfma_f32_32x32x16_bf16 v[96:111], v[156:159], v[144:147], v[96:111]
    ds_read_b64_tr_b16 v[140:141], v43 offset:8192
    ds_read_b64_tr_b16 v[142:143], v43 offset:9216
    v_mfma_f32_16x16x32_bf16 v[48:51], v[52:55], v[152:155], v[48:51]
    buffer_load_dwordx4 v29, s[40:43], s74 offen offset:1024 lds
    v_mfma_f32_32x32x16_bf16 v[112:127], v[156:159], v[148:151], v[112:127]
    s_waitcnt lgkmcnt(3)
    v_mfma_f32_32x32x16_bf16 v[64:79], v[136:139], v[128:131], v[64:79]
    ds_read_b128 v[144:147], v35 offset:32
    ds_read_b64_tr_b16 v[152:153], v41 offset:12288
    ds_read_b64_tr_b16 v[154:155], v41 offset:13312
    v_mfma_f32_16x16x32_bf16 v[44:47], v[52:55], v[128:131], v[44:47]
    buffer_load_dwordx4 v30, s[40:43], s74 offen offset:2048 lds
    s_waitcnt lgkmcnt(5)
    v_mfma_f32_32x32x16_bf16 v[80:95], v[136:139], v[132:135], v[80:95]
    ds_read_b128 v[148:151], v39 offset:32
    ds_read_b64_tr_b16 v[156:157], v43 offset:12288
    ds_read_b64_tr_b16 v[158:159], v43 offset:13312
    buffer_load_dwordx4 v31, s[40:43], s74 offen offset:3072 lds
    s_waitcnt lgkmcnt(6)
    v_mfma_f32_32x32x16_bf16 v[96:111], v[140:143], v[128:131], v[96:111]
    v_mfma_f32_16x16x32_bf16 v[48:51], v[52:55], v[136:139], v[48:51]
    v_mfma_f32_32x32x16_bf16 v[112:127], v[140:143], v[132:135], v[112:127]
    s_waitcnt lgkmcnt(0)
    s_waitcnt vmcnt(8)
    s_barrier
    v_mfma_f32_32x32x16_bf16 v[64:79], v[152:155], v[144:147], v[64:79]
    ds_read_b128 v[128:131], v32 offset:0
    ds_read_b64_tr_b16 v[136:137], v40 offset:0
    v_mfma_f32_16x16x32_bf16 v[44:47], v[52:55], v[144:147], v[44:47]
    v_mfma_f32_32x32x16_bf16 v[80:95], v[152:155], v[148:151], v[80:95]
    ds_read_b64_tr_b16 v[138:139], v40 offset:1024
    ds_read_b128 v[132:135], v36 offset:0
    v_mfma_f32_32x32x16_bf16 v[96:111], v[156:159], v[144:147], v[96:111]
    ds_read_b64_tr_b16 v[140:141], v42 offset:0
    ds_read_b64_tr_b16 v[142:143], v42 offset:1024
    v_mfma_f32_16x16x32_bf16 v[48:51], v[52:55], v[152:155], v[48:51]
    v_mfma_f32_32x32x16_bf16 v[112:127], v[156:159], v[148:151], v[112:127]
    s_lshl_b32 s73, s64, 7
    s_add_u32 s73, s73, s68
    s_mul_i32 s74, s64, 229376
    s_add_u32 s74, s74, s69
    s_add_u32 s64, s64, 1
    s_and_b32 s64, s64, 7
    s_waitcnt lgkmcnt(3)
    v_mfma_f32_32x32x16_bf16 v[64:79], v[136:139], v[128:131], v[64:79]
    ds_read_b128 v[144:147], v32 offset:32
    ds_read_b64_tr_b16 v[152:153], v40 offset:4096
    v_mfma_f32_16x16x32_bf16 v[44:47], v[52:55], v[128:131], v[44:47]
    s_mul_i32 s76, s60, 4160
    s_add_u32 m0, s76, 66048
    s_nop 0
    buffer_load_dwordx4 v24, s[36:39], s73 offen offset:0 lds
    s_waitcnt lgkmcnt(4)
    v_mfma_f32_32x32x16_bf16 v[80:95], v[136:139], v[132:135], v[80:95]
    ds_read_b64_tr_b16 v[154:155], v40 offset:5120
    ds_read_b128 v[148:151], v36 offset:32
    buffer_load_dwordx4 v25, s[36:39], s73 offen offset:1040 lds
    s_waitcnt lgkmcnt(4)
    v_mfma_f32_32x32x16_bf16 v[96:111], v[140:143], v[128:131], v[96:111]
    ds_read_b64_tr_b16 v[156:157], v42 offset:4096
    ds_read_b64_tr_b16 v[158:159], v42 offset:5120
    v_mfma_f32_16x16x32_bf16 v[48:51], v[52:55], v[136:139], v[48:51]
    buffer_load_dwordx4 v26, s[36:39], s73 offen offset:2080 lds
    v_mfma_f32_32x32x16_bf16 v[112:127], v[140:143], v[132:135], v[112:127]
    s_waitcnt lgkmcnt(3)
    v_mfma_f32_32x32x16_bf16 v[64:79], v[152:155], v[144:147], v[64:79]
    ds_read_b128 v[128:131], v33 offset:0
    ds_read_b64_tr_b16 v[136:137], v40 offset:8192
    v_mfma_f32_16x16x32_bf16 v[44:47], v[52:55], v[144:147], v[44:47]
    buffer_load_dwordx4 v27, s[36:39], s73 offen offset:3120 lds
    s_waitcnt lgkmcnt(4)
    v_mfma_f32_32x32x16_bf16 v[80:95], v[152:155], v[148:151], v[80:95]
    ds_read_b64_tr_b16 v[138:139], v40 offset:9216
    ds_read_b128 v[132:135], v37 offset:0
    s_mul_i32 s76, s60, 4096
    s_add_u32 m0, s76, 82688
    s_nop 0
    buffer_load_dwordx4 v28, s[40:43], s74 offen offset:0 lds
    s_waitcnt lgkmcnt(4)
    v_mfma_f32_32x32x16_bf16 v[96:111], v[156:159], v[144:147], v[96:111]
    ds_read_b64_tr_b16 v[140:141], v42 offset:8192
    ds_read_b64_tr_b16 v[142:143], v42 offset:9216
    v_mfma_f32_16x16x32_bf16 v[48:51], v[52:55], v[152:155], v[48:51]
    buffer_load_dwordx4 v29, s[40:43], s74 offen offset:1024 lds
    v_mfma_f32_32x32x16_bf16 v[112:127], v[156:159], v[148:151], v[112:127]
    s_waitcnt lgkmcnt(3)
    v_mfma_f32_32x32x16_bf16 v[64:79], v[136:139], v[128:131], v[64:79]
    ds_read_b128 v[144:147], v33 offset:32
    ds_read_b64_tr_b16 v[152:153], v40 offset:12288
    ds_read_b64_tr_b16 v[154:155], v40 offset:13312
    v_mfma_f32_16x16x32_bf16 v[44:47], v[52:55], v[128:131], v[44:47]
    buffer_load_dwordx4 v30, s[40:43], s74 offen offset:2048 lds
    s_waitcnt lgkmcnt(5)
    v_mfma_f32_32x32x16_bf16 v[80:95], v[136:139], v[132:135], v[80:95]
    ds_read_b128 v[148:151], v37 offset:32
    ds_read_b64_tr_b16 v[156:157], v42 offset:12288
    ds_read_b64_tr_b16 v[158:159], v42 offset:13312
    buffer_load_dwordx4 v31, s[40:43], s74 offen offset:3072 lds
    s_waitcnt lgkmcnt(6)
    v_mfma_f32_32x32x16_bf16 v[96:111], v[140:143], v[128:131], v[96:111]
    v_mfma_f32_16x16x32_bf16 v[48:51], v[52:55], v[136:139], v[48:51]
    v_mfma_f32_32x32x16_bf16 v[112:127], v[140:143], v[132:135], v[112:127]
    s_waitcnt lgkmcnt(0)
    s_waitcnt vmcnt(8)
    s_barrier
    v_mfma_f32_32x32x16_bf16 v[64:79], v[152:155], v[144:147], v[64:79]
    ds_read_b128 v[128:131], v32 offset:33024
    ds_read_b64_tr_b16 v[136:137], v40 offset:33024
    v_mfma_f32_16x16x32_bf16 v[44:47], v[52:55], v[144:147], v[44:47]
    v_mfma_f32_32x32x16_bf16 v[80:95], v[152:155], v[148:151], v[80:95]
    ds_read_b64_tr_b16 v[138:139], v40 offset:34048
    ds_read_b128 v[132:135], v36 offset:33024
    v_mfma_f32_32x32x16_bf16 v[96:111], v[156:159], v[144:147], v[96:111]
    ds_read_b64_tr_b16 v[140:141], v42 offset:33024
    ds_read_b64_tr_b16 v[142:143], v42 offset:34048
    v_mfma_f32_16x16x32_bf16 v[48:51], v[52:55], v[152:155], v[48:51]
    v_mfma_f32_32x32x16_bf16 v[112:127], v[156:159], v[148:151], v[112:127]
    s_lshl_b32 s73, s64, 7
    s_add_u32 s73, s73, s68
    s_mul_i32 s74, s64, 229376
    s_add_u32 s74, s74, s69
    s_add_u32 s64, s64, 1
    s_and_b32 s64, s64, 7
    s_waitcnt lgkmcnt(3)
    v_mfma_f32_32x32x16_bf16 v[64:79], v[136:139], v[128:131], v[64:79]
    ds_read_b128 v[144:147], v32 offset:33056
    ds_read_b64_tr_b16 v[152:153], v40 offset:37120
    v_mfma_f32_16x16x32_bf16 v[44:47], v[52:55], v[128:131], v[44:47]
    s_mul_i32 s76, s60, 4160
    s_add_u32 m0, s76, 0
    s_nop 0
    buffer_load_dwordx4 v24, s[36:39], s73 offen offset:0 lds
    s_waitcnt lgkmcnt(4)
    v_mfma_f32_32x32x16_bf16 v[80:95], v[136:139], v[132:135], v[80:95]
    ds_read_b64_tr_b16 v[154:155], v40 offset:38144
    ds_read_b128 v[148:151], v36 offset:33056
    buffer_load_dwordx4 v25, s[36:39], s73 offen offset:1040 lds
    s_waitcnt lgkmcnt(4)
    v_mfma_f32_32x32x16_bf16 v[96:111], v[140:143], v[128:131], v[96:111]
    ds_read_b64_tr_b16 v[156:157], v42 offset:37120
    ds_read_b64_tr_b16 v[158:159], v42 offset:38144
    v_mfma_f32_16x16x32_bf16 v[48:51], v[52:55], v[136:139], v[48:51]
    buffer_load_dwordx4 v26, s[36:39], s73 offen offset:2080 lds
    v_mfma_f32_32x32x16_bf16 v[112:127], v[140:143], v[132:135], v[112:127]
    s_waitcnt lgkmcnt(3)
    v_mfma_f32_32x32x16_bf16 v[64:79], v[152:155], v[144:147], v[64:79]
    ds_read_b128 v[128:131], v33 offset:33024
    ds_read_b64_tr_b16 v[136:137], v40 offset:41216
    v_mfma_f32_16x16x32_bf16 v[44:47], v[52:55], v[144:147], v[44:47]
    buffer_load_dwordx4 v27, s[36:39], s73 offen offset:3120 lds
    s_waitcnt lgkmcnt(4)
    v_mfma_f32_32x32x16_bf16 v[80:95], v[152:155], v[148:151], v[80:95]
    ds_read_b64_tr_b16 v[138:139], v40 offset:42240
    ds_read_b128 v[132:135], v37 offset:33024
    s_mul_i32 s76, s60, 4096
    s_add_u32 m0, s76, 16640
    s_nop 0
    buffer_load_dwordx4 v28, s[40:43], s74 offen offset:0 lds
    s_waitcnt lgkmcnt(4)
    v_mfma_f32_32x32x16_bf16 v[96:111], v[156:159], v[144:147], v[96:111]
    ds_read_b64_tr_b16 v[140:141], v42 offset:41216
    ds_read_b64_tr_b16 v[142:143], v42 offset:42240
    v_mfma_f32_16x16x32_bf16 v[48:51], v[52:55], v[152:155], v[48:51]
    buffer_load_dwordx4 v29, s[40:43], s74 offen offset:1024 lds
    v_mfma_f32_32x32x16_bf16 v[112:127], v[156:159], v[148:151], v[112:127]
    s_waitcnt lgkmcnt(3)
    v_mfma_f32_32x32x16_bf16 v[64:79], v[136:139], v[128:131], v[64:79]
    ds_read_b128 v[144:147], v33 offset:33056
    ds_read_b64_tr_b16 v[152:153], v40 offset:45312
    ds_read_b64_tr_b16 v[154:155], v40 offset:46336
    v_mfma_f32_16x16x32_bf16 v[44:47], v[52:55], v[128:131], v[44:47]
    buffer_load_dwordx4 v30, s[40:43], s74 offen offset:2048 lds
    s_waitcnt lgkmcnt(5)
    v_mfma_f32_32x32x16_bf16 v[80:95], v[136:139], v[132:135], v[80:95]
    ds_read_b128 v[148:151], v37 offset:33056
    ds_read_b64_tr_b16 v[156:157], v42 offset:45312
    ds_read_b64_tr_b16 v[158:159], v42 offset:46336
    buffer_load_dwordx4 v31, s[40:43], s74 offen offset:3072 lds
    s_waitcnt lgkmcnt(6)
    v_mfma_f32_32x32x16_bf16 v[96:111], v[140:143], v[128:131], v[96:111]
    v_mfma_f32_16x16x32_bf16 v[48:51], v[52:55], v[136:139], v[48:51]
    v_mfma_f32_32x32x16_bf16 v[112:127], v[140:143], v[132:135], v[112:127]
    s_waitcnt lgkmcnt(0)
    s_waitcnt vmcnt(8)
    s_barrier
    v_mfma_f32_32x32x16_bf16 v[64:79], v[152:155], v[144:147], v[64:79]
    ds_read_b128 v[128:131], v34 offset:0
    ds_read_b64_tr_b16 v[136:137], v41 offset:0
    v_mfma_f32_16x16x32_bf16 v[44:47], v[52:55], v[144:147], v[44:47]
    v_mfma_f32_32x32x16_bf16 v[80:95], v[152:155], v[148:151], v[80:95]
    ds_read_b64_tr_b16 v[138:139], v41 offset:1024
    ds_read_b128 v[132:135], v38 offset:0
    v_mfma_f32_32x32x16_bf16 v[96:111], v[156:159], v[144:147], v[96:111]
    ds_read_b64_tr_b16 v[140:141], v43 offset:0
    ds_read_b64_tr_b16 v[142:143], v43 offset:1024
    v_mfma_f32_16x16x32_bf16 v[48:51], v[52:55], v[152:155], v[48:51]
    v_mfma_f32_32x32x16_bf16 v[112:127], v[156:159], v[148:151], v[112:127]
    s_lshl_b32 s73, s64, 7
    s_add_u32 s73, s73, s68
    s_mul_i32 s74, s64, 229376
    s_add_u32 s74, s74, s69
    s_add_u32 s64, s64, 1
    s_and_b32 s64, s64, 7
    s_waitcnt lgkmcnt(3)
    v_mfma_f32_32x32x16_bf16 v[64:79], v[136:139], v[128:131], v[64:79]
    ds_read_b128 v[144:147], v34 offset:32
    ds_read_b64_tr_b16 v[152:153], v41 offset:4096
    v_mfma_f32_16x16x32_bf16 v[44:47], v[52:55], v[128:131], v[44:47]
    s_mul_i32 s76, s60, 4160
    s_add_u32 m0, s76, 33024
    s_nop 0
    buffer_load_dwordx4 v24, s[36:39], s73 offen offset:0 lds
    s_waitcnt lgkmcnt(4)
    v_mfma_f32_32x32x16_bf16 v[80:95], v[136:139], v[132:135], v[80:95]
    ds_read_b64_tr_b16 v[154:155], v41 offset:5120
    ds_read_b128 v[148:151], v38 offset:32
    buffer_load_dwordx4 v25, s[36:39], s73 offen offset:1040 lds
    s_waitcnt lgkmcnt(4)
    v_mfma_f32_32x32x16_bf16 v[96:111], v[140:143], v[128:131], v[96:111]
    ds_read_b64_tr_b16 v[156:157], v43 offset:4096
    ds_read_b64_tr_b16 v[158:159], v43 offset:5120
    v_mfma_f32_16x16x32_bf16 v[48:51], v[52:55], v[136:139], v[48:51]
    buffer_load_dwordx4 v26, s[36:39], s73 offen offset:2080 lds
    v_mfma_f32_32x32x16_bf16 v[112:127], v[140:143], v[132:135], v[112:127]
    s_waitcnt lgkmcnt(3)
    v_mfma_f32_32x32x16_bf16 v[64:79], v[152:155], v[144:147], v[64:79]
    ds_read_b128 v[128:131], v35 offset:0
    ds_read_b64_tr_b16 v[136:137], v41 offset:8192
    v_mfma_f32_16x16x32_bf16 v[44:47], v[52:55], v[144:147], v[44:47]
    buffer_load_dwordx4 v27, s[36:39], s73 offen offset:3120 lds
    s_waitcnt lgkmcnt(4)
    v_mfma_f32_32x32x16_bf16 v[80:95], v[152:155], v[148:151], v[80:95]
    ds_read_b64_tr_b16 v[138:139], v41 offset:9216
    ds_read_b128 v[132:135], v39 offset:0
    s_mul_i32 s76, s60, 4096
    s_add_u32 m0, s76, 49664
    s_nop 0
    buffer_load_dwordx4 v28, s[40:43], s74 offen offset:0 lds
    s_waitcnt lgkmcnt(4)
    v_mfma_f32_32x32x16_bf16 v[96:111], v[156:159], v[144:147], v[96:111]
    ds_read_b64_tr_b16 v[140:141], v43 offset:8192
    ds_read_b64_tr_b16 v[142:143], v43 offset:9216
    v_mfma_f32_16x16x32_bf16 v[48:51], v[52:55], v[152:155], v[48:51]
    buffer_load_dwordx4 v29, s[40:43], s74 offen offset:1024 lds
    v_mfma_f32_32x32x16_bf16 v[112:127], v[156:159], v[148:151], v[112:127]
    s_waitcnt lgkmcnt(3)
    v_mfma_f32_32x32x16_bf16 v[64:79], v[136:139], v[128:131], v[64:79]
    ds_read_b128 v[144:147], v35 offset:32
    ds_read_b64_tr_b16 v[152:153], v41 offset:12288
    ds_read_b64_tr_b16 v[154:155], v41 offset:13312
    v_mfma_f32_16x16x32_bf16 v[44:47], v[52:55], v[128:131], v[44:47]
    buffer_load_dwordx4 v30, s[40:43], s74 offen offset:2048 lds
    s_waitcnt lgkmcnt(5)
    v_mfma_f32_32x32x16_bf16 v[80:95], v[136:139], v[132:135], v[80:95]
    ds_read_b128 v[148:151], v39 offset:32
    ds_read_b64_tr_b16 v[156:157], v43 offset:12288
    ds_read_b64_tr_b16 v[158:159], v43 offset:13312
    buffer_load_dwordx4 v31, s[40:43], s74 offen offset:3072 lds
    s_waitcnt lgkmcnt(6)
    v_mfma_f32_32x32x16_bf16 v[96:111], v[140:143], v[128:131], v[96:111]
    v_mfma_f32_16x16x32_bf16 v[48:51], v[52:55], v[136:139], v[48:51]
    v_mfma_f32_32x32x16_bf16 v[112:127], v[140:143], v[132:135], v[112:127]
    s_waitcnt lgkmcnt(0)
    s_waitcnt vmcnt(8)
    s_barrier
    v_mfma_f32_32x32x16_bf16 v[64:79], v[152:155], v[144:147], v[64:79]
    ds_read_b128 v[128:131], v32 offset:0
    ds_read_b64_tr_b16 v[136:137], v40 offset:0
    v_mfma_f32_16x16x32_bf16 v[44:47], v[52:55], v[144:147], v[44:47]
    v_mfma_f32_32x32x16_bf16 v[80:95], v[152:155], v[148:151], v[80:95]
    ds_read_b64_tr_b16 v[138:139], v40 offset:1024
    ds_read_b128 v[132:135], v36 offset:0
    v_mfma_f32_32x32x16_bf16 v[96:111], v[156:159], v[144:147], v[96:111]
    ds_read_b64_tr_b16 v[140:141], v42 offset:0
    ds_read_b64_tr_b16 v[142:143], v42 offset:1024
    v_mfma_f32_16x16x32_bf16 v[48:51], v[52:55], v[152:155], v[48:51]
    v_mfma_f32_32x32x16_bf16 v[112:127], v[156:159], v[148:151], v[112:127]
    s_waitcnt lgkmcnt(3)
    v_mfma_f32_32x32x16_bf16 v[64:79], v[136:139], v[128:131], v[64:79]
    ds_read_b128 v[144:147], v32 offset:32
    ds_read_b64_tr_b16 v[152:153], v40 offset:4096
    v_mfma_f32_16x16x32_bf16 v[44:47], v[52:55], v[128:131], v[44:47]
    s_lshl_b32 s76, s60, 13
    s_add_u32 m0, s76, 66048
    s_add_u32 s78, s9, 65536
    buffer_load_dwordx4 v10, s[44:47], s78 offen offset:0 lds
    s_waitcnt lgkmcnt(4)
    v_mfma_f32_32x32x16_bf16 v[80:95], v[136:139], v[132:135], v[80:95]
    ds_read_b64_tr_b16 v[154:155], v40 offset:5120
    ds_read_b128 v[148:151], v36 offset:32
    buffer_load_dwordx4 v11, s[44:47], s78 offen offset:1024 lds
    s_waitcnt lgkmcnt(4)
    v_mfma_f32_32x32x16_bf16 v[96:111], v[140:143], v[128:131], v[96:111]
    ds_read_b64_tr_b16 v[156:157], v42 offset:4096
    ds_read_b64_tr_b16 v[158:159], v42 offset:5120
    v_mfma_f32_16x16x32_bf16 v[48:51], v[52:55], v[136:139], v[48:51]
    buffer_load_dwordx4 v12, s[44:47], s78 offen offset:2048 lds
    v_mfma_f32_32x32x16_bf16 v[112:127], v[140:143], v[132:135], v[112:127]
    buffer_load_dwordx4 v13, s[44:47], s78 offen offset:3072 lds
    s_waitcnt lgkmcnt(3)
    v_mfma_f32_32x32x16_bf16 v[64:79], v[152:155], v[144:147], v[64:79]
    ds_read_b128 v[128:131], v33 offset:0
    ds_read_b64_tr_b16 v[136:137], v40 offset:8192
    v_mfma_f32_16x16x32_bf16 v[44:47], v[52:55], v[144:147], v[44:47]
    s_lshl_b32 s76, s60, 13
    s_add_u32 m0, s76, 70144
    s_add_u32 s78, s9, 98304
    buffer_load_dwordx4 v10, s[44:47], s78 offen offset:0 lds
    s_waitcnt lgkmcnt(4)
    v_mfma_f32_32x32x16_bf16 v[80:95], v[152:155], v[148:151], v[80:95]
    ds_read_b64_tr_b16 v[138:139], v40 offset:9216
    ds_read_b128 v[132:135], v37 offset:0
    buffer_load_dwordx4 v11, s[44:47], s78 offen offset:1024 lds
    s_waitcnt lgkmcnt(4)
    v_mfma_f32_32x32x16_bf16 v[96:111], v[156:159], v[144:147], v[96:111]
    ds_read_b64_tr_b16 v[140:141], v42 offset:8192
    ds_read_b64_tr_b16 v[142:143], v42 offset:9216
    v_mfma_f32_16x16x32_bf16 v[48:51], v[52:55], v[152:155], v[48:51]
    buffer_load_dwordx4 v12, s[44:47], s78 offen offset:2048 lds
    v_mfma_f32_32x32x16_bf16 v[112:127], v[156:159], v[148:151], v[112:127]
    buffer_load_dwordx4 v13, s[44:47], s78 offen offset:3072 lds
    s_waitcnt lgkmcnt(3)
    v_mfma_f32_32x32x16_bf16 v[64:79], v[136:139], v[128:131], v[64:79]
    ds_read_b128 v[144:147], v33 offset:32
    ds_read_b64_tr_b16 v[152:153], v40 offset:12288
    ds_read_b64_tr_b16 v[154:155], v40 offset:13312
    v_mfma_f32_16x16x32_bf16 v[44:47], v[52:55], v[128:131], v[44:47]
    s_lshl_b32 s76, s60, 13
    s_add_u32 m0, s76, 99072
    s_add_u32 s78, s9, 0
    buffer_load_dwordx4 v10, s[44:47], s78 offen offset:0 lds
    s_waitcnt lgkmcnt(5)
    v_mfma_f32_32x32x16_bf16 v[80:95], v[136:139], v[132:135], v[80:95]
    ds_read_b128 v[148:151], v37 offset:32
    ds_read_b64_tr_b16 v[156:157], v42 offset:12288
    ds_read_b64_tr_b16 v[158:159], v42 offset:13312
    buffer_load_dwordx4 v11, s[44:47], s78 offen offset:1024 lds
    s_waitcnt lgkmcnt(6)
    v_mfma_f32_32x32x16_bf16 v[96:111], v[140:143], v[128:131], v[96:111]
    v_mfma_f32_16x16x32_bf16 v[48:51], v[52:55], v[136:139], v[48:51]
    buffer_load_dwordx4 v12, s[44:47], s78 offen offset:2048 lds
    v_mfma_f32_32x32x16_bf16 v[112:127], v[140:143], v[132:135], v[112:127]
    buffer_load_dwordx4 v13, s[44:47], s78 offen offset:3072 lds
    s_waitcnt lgkmcnt(0)
    s_waitcnt vmcnt(12)
    s_barrier
    v_mfma_f32_32x32x16_bf16 v[64:79], v[152:155], v[144:147], v[64:79]
    ds_read_b128 v[128:131], v32 offset:33024
    ds_read_b64_tr_b16 v[136:137], v40 offset:33024
    v_mfma_f32_16x16x32_bf16 v[44:47], v[52:55], v[144:147], v[44:47]
    v_mfma_f32_32x32x16_bf16 v[80:95], v[152:155], v[148:151], v[80:95]
    ds_read_b64_tr_b16 v[138:139], v40 offset:34048
    ds_read_b128 v[132:135], v36 offset:33024
    v_mfma_f32_32x32x16_bf16 v[96:111], v[156:159], v[144:147], v[96:111]
    ds_read_b64_tr_b16 v[140:141], v42 offset:33024
    ds_read_b64_tr_b16 v[142:143], v42 offset:34048
    v_mfma_f32_16x16x32_bf16 v[48:51], v[52:55], v[152:155], v[48:51]
    v_mfma_f32_32x32x16_bf16 v[112:127], v[156:159], v[148:151], v[112:127]
    s_waitcnt lgkmcnt(3)
    v_mfma_f32_32x32x16_bf16 v[64:79], v[136:139], v[128:131], v[64:79]
    ds_read_b128 v[144:147], v32 offset:33056
    ds_read_b64_tr_b16 v[152:153], v40 offset:37120
    v_mfma_f32_16x16x32_bf16 v[44:47], v[52:55], v[128:131], v[44:47]
    s_lshl_b32 s76, s60, 13
    s_add_u32 m0, s76, 0
    s_add_u32 s78, s9, 131072
    buffer_load_dwordx4 v10, s[44:47], s78 offen offset:0 lds
    s_waitcnt lgkmcnt(4)
    v_mfma_f32_32x32x16_bf16 v[80:95], v[136:139], v[132:135], v[80:95]
    ds_read_b64_tr_b16 v[154:155], v40 offset:38144
    ds_read_b128 v[148:151], v36 offset:33056
    buffer_load_dwordx4 v11, s[44:47], s78 offen offset:1024 lds
    s_waitcnt lgkmcnt(4)
    v_mfma_f32_32x32x16_bf16 v[96:111], v[140:143], v[128:131], v[96:111]
    ds_read_b64_tr_b16 v[156:157], v42 offset:37120
    ds_read_b64_tr_b16 v[158:159], v42 offset:38144
    v_mfma_f32_16x16x32_bf16 v[48:51], v[52:55], v[136:139], v[48:51]
    buffer_load_dwordx4 v12, s[44:47], s78 offen offset:2048 lds
    v_mfma_f32_32x32x16_bf16 v[112:127], v[140:143], v[132:135], v[112:127]
    buffer_load_dwordx4 v13, s[44:47], s78 offen offset:3072 lds
    s_waitcnt lgkmcnt(3)
    v_mfma_f32_32x32x16_bf16 v[64:79], v[152:155], v[144:147], v[64:79]
    ds_read_b128 v[128:131], v33 offset:33024
    ds_read_b64_tr_b16 v[136:137], v40 offset:41216
    v_mfma_f32_16x16x32_bf16 v[44:47], v[52:55], v[144:147], v[44:47]
    s_lshl_b32 s76, s60, 13
    s_add_u32 m0, s76, 4096
    s_add_u32 s78, s9, 163840
    buffer_load_dwordx4 v10, s[44:47], s78 offen offset:0 lds
    s_waitcnt lgkmcnt(4)
    v_mfma_f32_32x32x16_bf16 v[80:95], v[152:155], v[148:151], v[80:95]
    ds_read_b64_tr_b16 v[138:139], v40 offset:42240
    ds_read_b128 v[132:135], v37 offset:33024
    buffer_load_dwordx4 v11, s[44:47], s78 offen offset:1024 lds
    s_waitcnt lgkmcnt(4)
    v_mfma_f32_32x32x16_bf16 v[96:111], v[156:159], v[144:147], v[96:111]
    ds_read_b64_tr_b16 v[140:141], v42 offset:41216
    ds_read_b64_tr_b16 v[142:143], v42 offset:42240
    v_mfma_f32_16x16x32_bf16 v[48:51], v[52:55], v[152:155], v[48:51]
    buffer_load_dwordx4 v12, s[44:47], s78 offen offset:2048 lds
    v_mfma_f32_32x32x16_bf16 v[112:127], v[156:159], v[148:151], v[112:127]
    buffer_load_dwordx4 v13, s[44:47], s78 offen offset:3072 lds
    s_waitcnt lgkmcnt(3)
    v_mfma_f32_32x32x16_bf16 v[64:79], v[136:139], v[128:131], v[64:79]
    ds_read_b128 v[144:147], v33 offset:33056
    ds_read_b64_tr_b16 v[152:153], v40 offset:45312
    ds_read_b64_tr_b16 v[154:155], v40 offset:46336
    v_mfma_f32_16x16x32_bf16 v[44:47], v[52:55], v[128:131], v[44:47]
    s_lshl_b32 s76, s60, 13
    s_add_u32 m0, s76, 103168
    s_add_u32 s78, s9, 32768
    buffer_load_dwordx4 v10, s[44:47], s78 offen offset:0 lds
    s_waitcnt lgkmcnt(5)
    v_mfma_f32_32x32x16_bf16 v[80:95], v[136:139], v[132:135], v[80:95]
    ds_read_b128 v[148:151], v37 offset:33056
    ds_read_b64_tr_b16 v[156:157], v42 offset:45312
    ds_read_b64_tr_b16 v[158:159], v42 offset:46336
    buffer_load_dwordx4 v11, s[44:47], s78 offen offset:1024 lds
    s_waitcnt lgkmcnt(6)
    v_mfma_f32_32x32x16_bf16 v[96:111], v[140:143], v[128:131], v[96:111]
    v_mfma_f32_16x16x32_bf16 v[48:51], v[52:55], v[136:139], v[48:51]
    buffer_load_dwordx4 v12, s[44:47], s78 offen offset:2048 lds
    v_mfma_f32_32x32x16_bf16 v[112:127], v[140:143], v[132:135], v[112:127]
    buffer_load_dwordx4 v13, s[44:47], s78 offen offset:3072 lds
    s_waitcnt lgkmcnt(0)
    v_mfma_f32_16x16x32_bf16 v[44:47], v[52:55], v[144:147], v[44:47]
    v_mfma_f32_16x16x32_bf16 v[48:51], v[52:55], v[152:155], v[48:51]
    v_mfma_f32_32x32x16_bf16 v[64:79], v[152:155], v[144:147], v[64:79]
    v_mfma_f32_32x32x16_bf16 v[80:95], v[152:155], v[148:151], v[80:95]
    v_and_b32 v4, 31, v1
    v_lshlrev_b32 v4, 2, v4
    v_and_b32 v2, 16, v1
    v_cmp_ne_u32 vcc, 0, v2
    s_and_b32 s73, s60, 1
    s_lshr_b32 s74, s60, 1
    s_lshl_b32 s75, s73, 1
    s_add_u32 s75, s75, s74
    s_lshl_b32 s75, s75, 7
    s_add_u32 s75, s75, 136960
    s_lshl_b32 s76, s60, 7
    s_add_u32 s76, s76, 137472
    v_cndmask_b32 v2, v44, v45, vcc
    v_cndmask_b32 v3, v48, v49, vcc
    v_mul_f32 v2, 0x3b000000, v2
    v_add_u32 v6, s76, v4
    v_cvt_pk_bf16_f32 v2, v2, v2
    v_add_u32 v5, s75, v4
    v_and_b32 v56, 0xffff0000, v2
    s_mov_b64 exec, 0xffffffff
    ds_write_b32 v6, v3
    ds_write_b32 v5, v56
    s_mov_b64 exec, -1
    v_xor_b32 v5, 128, v5
    v_lshrrev_b32 v7, 5, v1
    v_lshl_add_u32 v6, v7, 4, s76
    v_xor_b32 v7, 128, v6
    v_mfma_f32_32x32x16_bf16 v[96:111], v[156:159], v[144:147], v[96:111]
    v_mfma_f32_32x32x16_bf16 v[112:127], v[156:159], v[148:151], v[112:127]
    s_waitcnt lgkmcnt(0)
    s_setprio 3
    s_barrier
    ds_read_b32 v58, v5
    ds_read_b128 v[24:27], v6 offset:0
    ds_read_b128 v[28:31], v6 offset:32
    ds_read_b128 v[32:35], v6 offset:64
    ds_read_b128 v[36:39], v6 offset:96
    ds_read_b128 v[40:43], v7 offset:0
    ds_read_b128 v[44:47], v7 offset:32
    ds_read_b128 v[48:51], v7 offset:64
    ds_read_b128 v[52:55], v7 offset:96
    s_lshl_b32 s76, s61, 1
    s_add_u32 s76, s76, s73
    s_lshl_b32 s75, s62, 1
    s_add_u32 s75, s75, s74
    s_mul_i32 s100, s75, 37
    s_lshr_b32 s100, s100, 8
    s_lshl2_add_u32 s8, s76, s100
    s_lshl_b32 s8, s8, 5
    s_mul_i32 s100, s100, 7
    s_sub_u32 s100, s75, s100
    s_add_u32 s8, s8, s100
    s_lshl_b32 s8, s8, 2
    s_add_u32 s8, s8, 0xb20000
    s_mul_i32 s76, s76, 56
    s_add_u32 s76, s76, s75
    s_lshl_b32 s76, s76, 12
    s_mul_i32 s74, s74, 114688
    s_lshl_b32 s73, s73, 11
    s_add_u32 s4, s76, s74
    s_sub_u32 s5, s76, s74
    s_add_u32 s5, s5, 114688
    s_sub_u32 s6, s4, s73
    s_add_u32 s6, s6, 2048
    s_add_u32 s4, s4, s73
    s_sub_u32 s7, s5, s73
    s_add_u32 s7, s7, 2048
    s_add_u32 s5, s5, s73
    s_waitcnt lgkmcnt(6)
    v_pk_fma_f32 v[64:65], v[24:25], v[56:57], v[64:65] op_sel_hi:[1,0,1] neg_lo:[0,1,0] neg_hi:[0,1,0]
    v_pk_fma_f32 v[66:67], v[26:27], v[56:57], v[66:67] op_sel_hi:[1,0,1] neg_lo:[0,1,0] neg_hi:[0,1,0]
    v_pk_fma_f32 v[68:69], v[28:29], v[56:57], v[68:69] op_sel_hi:[1,0,1] neg_lo:[0,1,0] neg_hi:[0,1,0]
    v_pk_fma_f32 v[70:71], v[30:31], v[56:57], v[70:71] op_sel_hi:[1,0,1] neg_lo:[0,1,0] neg_hi:[0,1,0]
    v_cvt_pk_bf16_f32 v128, v64, v65
    v_cvt_pk_bf16_f32 v129, v66, v67
    v_cvt_pk_bf16_f32 v130, v68, v69
    v_cvt_pk_bf16_f32 v131, v70, v71
    v_pk_max_i16 v128, v128, 0
    v_pk_max_i16 v129, v129, 0
    v_pk_max_i16 v130, v130, 0
    v_pk_max_i16 v131, v131, 0
    buffer_store_dwordx4 v[128:131], v18, s[52:55], s4 offen offset:0 sc1
    v_pk_fma_f32 v[80:81], v[24:25], v[58:59], v[80:81] op_sel_hi:[1,0,1] neg_lo:[0,1,0] neg_hi:[0,1,0]
    v_pk_fma_f32 v[82:83], v[26:27], v[58:59], v[82:83] op_sel_hi:[1,0,1] neg_lo:[0,1,0] neg_hi:[0,1,0]
    v_pk_fma_f32 v[84:85], v[28:29], v[58:59], v[84:85] op_sel_hi:[1,0,1] neg_lo:[0,1,0] neg_hi:[0,1,0]
    v_pk_fma_f32 v[86:87], v[30:31], v[58:59], v[86:87] op_sel_hi:[1,0,1] neg_lo:[0,1,0] neg_hi:[0,1,0]
    v_cvt_pk_bf16_f32 v132, v80, v81
    v_cvt_pk_bf16_f32 v133, v82, v83
    v_cvt_pk_bf16_f32 v134, v84, v85
    v_cvt_pk_bf16_f32 v135, v86, v87
    v_pk_max_i16 v132, v132, 0
    v_pk_max_i16 v133, v133, 0
    v_pk_max_i16 v134, v134, 0
    v_pk_max_i16 v135, v135, 0
    buffer_store_dwordx4 v[132:135], v18, s[52:55], s5 offen offset:0 sc1
    s_waitcnt lgkmcnt(4)
    v_pk_fma_f32 v[72:73], v[32:33], v[56:57], v[72:73] op_sel_hi:[1,0,1] neg_lo:[0,1,0] neg_hi:[0,1,0]
    v_pk_fma_f32 v[74:75], v[34:35], v[56:57], v[74:75] op_sel_hi:[1,0,1] neg_lo:[0,1,0] neg_hi:[0,1,0]
    v_pk_fma_f32 v[76:77], v[36:37], v[56:57], v[76:77] op_sel_hi:[1,0,1] neg_lo:[0,1,0] neg_hi:[0,1,0]
    v_pk_fma_f32 v[78:79], v[38:39], v[56:57], v[78:79] op_sel_hi:[1,0,1] neg_lo:[0,1,0] neg_hi:[0,1,0]
    v_cvt_pk_bf16_f32 v136, v72, v73
    v_cvt_pk_bf16_f32 v137, v74, v75
    v_cvt_pk_bf16_f32 v138, v76, v77
    v_cvt_pk_bf16_f32 v139, v78, v79
    v_pk_max_i16 v136, v136, 0
    v_pk_max_i16 v137, v137, 0
    v_pk_max_i16 v138, v138, 0
    v_pk_max_i16 v139, v139, 0
    buffer_store_dwordx4 v[136:139], v18, s[52:55], s4 offen offset:1024 sc1
    v_pk_fma_f32 v[88:89], v[32:33], v[58:59], v[88:89] op_sel_hi:[1,0,1] neg_lo:[0,1,0] neg_hi:[0,1,0]
    v_pk_fma_f32 v[90:91], v[34:35], v[58:59], v[90:91] op_sel_hi:[1,0,1] neg_lo:[0,1,0] neg_hi:[0,1,0]
    v_pk_fma_f32 v[92:93], v[36:37], v[58:59], v[92:93] op_sel_hi:[1,0,1] neg_lo:[0,1,0] neg_hi:[0,1,0]
    v_pk_fma_f32 v[94:95], v[38:39], v[58:59], v[94:95] op_sel_hi:[1,0,1] neg_lo:[0,1,0] neg_hi:[0,1,0]
    v_cvt_pk_bf16_f32 v140, v88, v89
    v_cvt_pk_bf16_f32 v141, v90, v91
    v_cvt_pk_bf16_f32 v142, v92, v93
    v_cvt_pk_bf16_f32 v143, v94, v95
    v_pk_max_i16 v140, v140, 0
    v_pk_max_i16 v141, v141, 0
    v_pk_max_i16 v142, v142, 0
    v_pk_max_i16 v143, v143, 0
    buffer_store_dwordx4 v[140:143], v18, s[52:55], s5 offen offset:1024 sc1
    s_waitcnt lgkmcnt(2)
    v_pk_fma_f32 v[96:97], v[40:41], v[56:57], v[96:97] op_sel_hi:[1,0,1] neg_lo:[0,1,0] neg_hi:[0,1,0]
    v_pk_fma_f32 v[98:99], v[42:43], v[56:57], v[98:99] op_sel_hi:[1,0,1] neg_lo:[0,1,0] neg_hi:[0,1,0]
    v_pk_fma_f32 v[100:101], v[44:45], v[56:57], v[100:101] op_sel_hi:[1,0,1] neg_lo:[0,1,0] neg_hi:[0,1,0]
    v_pk_fma_f32 v[102:103], v[46:47], v[56:57], v[102:103] op_sel_hi:[1,0,1] neg_lo:[0,1,0] neg_hi:[0,1,0]
    v_cvt_pk_bf16_f32 v144, v96, v97
    v_cvt_pk_bf16_f32 v145, v98, v99
    v_cvt_pk_bf16_f32 v146, v100, v101
    v_cvt_pk_bf16_f32 v147, v102, v103
    v_pk_max_i16 v144, v144, 0
    v_pk_max_i16 v145, v145, 0
    v_pk_max_i16 v146, v146, 0
    v_pk_max_i16 v147, v147, 0
    buffer_store_dwordx4 v[144:147], v18, s[52:55], s6 offen offset:0 sc1
    v_pk_fma_f32 v[112:113], v[40:41], v[58:59], v[112:113] op_sel_hi:[1,0,1] neg_lo:[0,1,0] neg_hi:[0,1,0]
    v_pk_fma_f32 v[114:115], v[42:43], v[58:59], v[114:115] op_sel_hi:[1,0,1] neg_lo:[0,1,0] neg_hi:[0,1,0]
    v_pk_fma_f32 v[116:117], v[44:45], v[58:59], v[116:117] op_sel_hi:[1,0,1] neg_lo:[0,1,0] neg_hi:[0,1,0]
    v_pk_fma_f32 v[118:119], v[46:47], v[58:59], v[118:119] op_sel_hi:[1,0,1] neg_lo:[0,1,0] neg_hi:[0,1,0]
    v_cvt_pk_bf16_f32 v148, v112, v113
    v_cvt_pk_bf16_f32 v149, v114, v115
    v_cvt_pk_bf16_f32 v150, v116, v117
    v_cvt_pk_bf16_f32 v151, v118, v119
    v_pk_max_i16 v148, v148, 0
    v_pk_max_i16 v149, v149, 0
    v_pk_max_i16 v150, v150, 0
    v_pk_max_i16 v151, v151, 0
    buffer_store_dwordx4 v[148:151], v18, s[52:55], s7 offen offset:0 sc1
    s_waitcnt lgkmcnt(0)
    v_pk_fma_f32 v[104:105], v[48:49], v[56:57], v[104:105] op_sel_hi:[1,0,1] neg_lo:[0,1,0] neg_hi:[0,1,0]
    v_pk_fma_f32 v[106:107], v[50:51], v[56:57], v[106:107] op_sel_hi:[1,0,1] neg_lo:[0,1,0] neg_hi:[0,1,0]
    v_pk_fma_f32 v[108:109], v[52:53], v[56:57], v[108:109] op_sel_hi:[1,0,1] neg_lo:[0,1,0] neg_hi:[0,1,0]
    v_pk_fma_f32 v[110:111], v[54:55], v[56:57], v[110:111] op_sel_hi:[1,0,1] neg_lo:[0,1,0] neg_hi:[0,1,0]
    v_cvt_pk_bf16_f32 v152, v104, v105
    v_cvt_pk_bf16_f32 v153, v106, v107
    v_cvt_pk_bf16_f32 v154, v108, v109
    v_cvt_pk_bf16_f32 v155, v110, v111
    v_pk_max_i16 v152, v152, 0
    v_pk_max_i16 v153, v153, 0
    v_pk_max_i16 v154, v154, 0
    v_pk_max_i16 v155, v155, 0
    buffer_store_dwordx4 v[152:155], v18, s[52:55], s6 offen offset:1024 sc1
    v_pk_fma_f32 v[120:121], v[48:49], v[58:59], v[120:121] op_sel_hi:[1,0,1] neg_lo:[0,1,0] neg_hi:[0,1,0]
    v_pk_fma_f32 v[122:123], v[50:51], v[58:59], v[122:123] op_sel_hi:[1,0,1] neg_lo:[0,1,0] neg_hi:[0,1,0]
    v_pk_fma_f32 v[124:125], v[52:53], v[58:59], v[124:125] op_sel_hi:[1,0,1] neg_lo:[0,1,0] neg_hi:[0,1,0]
    v_pk_fma_f32 v[126:127], v[54:55], v[58:59], v[126:127] op_sel_hi:[1,0,1] neg_lo:[0,1,0] neg_hi:[0,1,0]
    v_cvt_pk_bf16_f32 v156, v120, v121
    v_cvt_pk_bf16_f32 v157, v122, v123
    v_cvt_pk_bf16_f32 v158, v124, v125
    v_cvt_pk_bf16_f32 v159, v126, v127
    v_pk_max_i16 v156, v156, 0
    v_pk_max_i16 v157, v157, 0
    v_pk_max_i16 v158, v158, 0
    v_pk_max_i16 v159, v159, 0
    buffer_store_dwordx4 v[156:159], v18, s[52:55], s7 offen offset:1024 sc1
    s_waitcnt vmcnt(22)
    ds_read_b64_tr_b16 v[224:225], v16 offset:33024
    ds_read_b64_tr_b16 v[226:227], v16 offset:34048
    ds_read_b64_tr_b16 v[228:229], v17 offset:33024
    ds_read_b64_tr_b16 v[230:231], v17 offset:34048
    s_waitcnt vmcnt(20)
    ds_read_b64_tr_b16 v[232:233], v16 offset:35072
    ds_read_b64_tr_b16 v[234:235], v16 offset:36096
    ds_read_b64_tr_b16 v[236:237], v17 offset:35072
    ds_read_b64_tr_b16 v[238:239], v17 offset:36096
    s_waitcnt vmcnt(10)
    ds_read_b64_tr_b16 v[240:241], v16 offset:37120
    ds_read_b64_tr_b16 v[242:243], v16 offset:38144
    ds_read_b64_tr_b16 v[244:245], v17 offset:37120
    ds_read_b64_tr_b16 v[246:247], v17 offset:38144
    s_waitcnt vmcnt(8)
    ds_read_b64_tr_b16 v[248:249], v16 offset:39168
    ds_read_b64_tr_b16 v[250:251], v16 offset:40192
    ds_read_b64_tr_b16 v[252:253], v17 offset:39168
    ds_read_b64_tr_b16 v[254:255], v17 offset:40192
    s_waitcnt lgkmcnt(0)
    s_lshl_b32 s76, s60, 13
    s_add_u32 m0, s76, 99072
    s_add_u32 s78, s9, 196608
    buffer_load_dwordx4 v10, s[44:47], s78 offen offset:0 lds
    buffer_load_dwordx4 v11, s[44:47], s78 offen offset:1024 lds
    buffer_load_dwordx4 v12, s[44:47], s78 offen offset:2048 lds
    buffer_load_dwordx4 v13, s[44:47], s78 offen offset:3072 lds
    s_lshl_b32 s76, s60, 13
    s_add_u32 m0, s76, 103168
    s_add_u32 s78, s9, 229376
    buffer_load_dwordx4 v10, s[44:47], s78 offen offset:0 lds
    buffer_load_dwordx4 v11, s[44:47], s78 offen offset:1024 lds
    buffer_load_dwordx4 v12, s[44:47], s78 offen offset:2048 lds
    buffer_load_dwordx4 v13, s[44:47], s78 offen offset:3072 lds
    s_setprio 1
L_JOIN:
    ds_read_b64_tr_b16 v[128:129], v16 offset:0
    ds_read_b64_tr_b16 v[130:131], v16 offset:1024
    ds_read_b64_tr_b16 v[132:133], v17 offset:0
    ds_read_b64_tr_b16 v[134:135], v17 offset:1024
    ds_read_b64_tr_b16 v[136:137], v16 offset:2048
    ds_read_b64_tr_b16 v[138:139], v16 offset:3072
    ds_read_b64_tr_b16 v[140:141], v17 offset:2048
    ds_read_b64_tr_b16 v[142:143], v17 offset:3072
    ds_read_b64_tr_b16 v[144:145], v16 offset:4096
    ds_read_b64_tr_b16 v[146:147], v16 offset:5120
    ds_read_b64_tr_b16 v[148:149], v17 offset:4096
    ds_read_b64_tr_b16 v[150:151], v17 offset:5120
    ds_read_b64_tr_b16 v[152:153], v16 offset:6144
    ds_read_b64_tr_b16 v[154:155], v16 offset:7168
    ds_read_b64_tr_b16 v[156:157], v17 offset:6144
    ds_read_b64_tr_b16 v[158:159], v17 offset:7168
    s_waitcnt lgkmcnt(0)
    s_lshl_b32 s76, s60, 13
    s_add_u32 m0, s76, 66048
    s_add_u32 s78, s9, 262144
    buffer_load_dwordx4 v10, s[44:47], s78 offen offset:0 lds
    buffer_load_dwordx4 v11, s[44:47], s78 offen offset:1024 lds
    buffer_load_dwordx4 v12, s[44:47], s78 offen offset:2048 lds
    buffer_load_dwordx4 v13, s[44:47], s78 offen offset:3072 lds
    s_lshl_b32 s76, s60, 13
    s_add_u32 m0, s76, 70144
    s_add_u32 s78, s9, 294912
    buffer_load_dwordx4 v10, s[44:47], s78 offen offset:0 lds
    buffer_load_dwordx4 v11, s[44:47], s78 offen offset:1024 lds
    buffer_load_dwordx4 v12, s[44:47], s78 offen offset:2048 lds
    buffer_load_dwordx4 v13, s[44:47], s78 offen offset:3072 lds
    s_lshl2_add_u32 s68, s66, s60
    s_lshl_b32 s68, s68, 7
    s_add_u32 s68, s68, 0xb20000
    s_cmp_eq_u32 s67, 3
    s_cbranch_scc1 L_nopub_2
    s_mov_b32 s77, 0
L_nretry_3:
    v_readfirstlane_b32 s65, v20
    s_add_u32 s77, s77, 1
    s_nop 0
    s_cmp_lg_u32 s65, 0
    s_cbranch_scc1 L_nok_4
    s_cmp_ge_u32 s77, 20000
    s_cbranch_scc1 L_nok_4
    buffer_load_dword v20, off, s[56:59], 0 sc1
    s_waitcnt vmcnt(0)
    s_branch L_nretry_3
L_nok_4:
    s_waitcnt vmcnt(16)
    s_mov_b32 s3, s65
    s_atomic_swap s3, s[32:33], s8
L_nopub_2:
    ds_read_b64_tr_b16 v[160:161], v14 offset:0
    ds_read_b64_tr_b16 v[162:163], v14 offset:1024
    ds_read_b64_tr_b16 v[164:165], v15 offset:0
    ds_read_b64_tr_b16 v[166:167], v15 offset:1024
    ds_read_b64_tr_b16 v[168:169], v14 offset:2048
    ds_read_b64_tr_b16 v[170:171], v14 offset:3072
    ds_read_b64_tr_b16 v[172:173], v15 offset:2048
    ds_read_b64_tr_b16 v[174:175], v15 offset:3072
    ds_read_b64_tr_b16 v[176:177], v14 offset:4096
    ds_read_b64_tr_b16 v[178:179], v14 offset:5120
    ds_read_b64_tr_b16 v[180:181], v15 offset:4096
    ds_read_b64_tr_b16 v[182:183], v15 offset:5120
    ds_read_b64_tr_b16 v[184:185], v14 offset:6144
    ds_read_b64_tr_b16 v[186:187], v14 offset:7168
    ds_read_b64_tr_b16 v[188:189], v15 offset:6144
    ds_read_b64_tr_b16 v[190:191], v15 offset:7168
    s_waitcnt lgkmcnt(0)
    s_lshl_b32 s76, s60, 13
    s_add_u32 m0, s76, 0
    s_add_u32 s78, s9, 327680
    buffer_load_dwordx4 v10, s[44:47], s78 offen offset:0 lds
    buffer_load_dwordx4 v11, s[44:47], s78 offen offset:1024 lds
    buffer_load_dwordx4 v12, s[44:47], s78 offen offset:2048 lds
    buffer_load_dwordx4 v13, s[44:47], s78 offen offset:3072 lds
    s_lshl_b32 s76, s60, 13
    s_add_u32 m0, s76, 4096
    s_add_u32 s78, s9, 360448
    buffer_load_dwordx4 v10, s[44:47], s78 offen offset:0 lds
    buffer_load_dwordx4 v11, s[44:47], s78 offen offset:1024 lds
    buffer_load_dwordx4 v12, s[44:47], s78 offen offset:2048 lds
    buffer_load_dwordx4 v13, s[44:47], s78 offen offset:3072 lds
    s_waitcnt vmcnt(22)
    ds_read_b64_tr_b16 v[192:193], v16 offset:33024
    ds_read_b64_tr_b16 v[194:195], v16 offset:34048
    ds_read_b64_tr_b16 v[196:197], v17 offset:33024
    ds_read_b64_tr_b16 v[198:199], v17 offset:34048
    s_waitcnt vmcnt(20)
    ds_read_b64_tr_b16 v[200:201], v16 offset:35072
    ds_read_b64_tr_b16 v[202:203], v16 offset:36096
    ds_read_b64_tr_b16 v[204:205], v17 offset:35072
    ds_read_b64_tr_b16 v[206:207], v17 offset:36096
    s_waitcnt vmcnt(18)
    ds_read_b64_tr_b16 v[208:209], v16 offset:37120
    ds_read_b64_tr_b16 v[210:211], v16 offset:38144
    ds_read_b64_tr_b16 v[212:213], v17 offset:37120
    ds_read_b64_tr_b16 v[214:215], v17 offset:38144
    s_waitcnt vmcnt(16)
    ds_read_b64_tr_b16 v[216:217], v16 offset:39168
    ds_read_b64_tr_b16 v[218:219], v16 offset:40192
    ds_read_b64_tr_b16 v[220:221], v17 offset:39168
    ds_read_b64_tr_b16 v[222:223], v17 offset:40192
    s_waitcnt lgkmcnt(0)
    s_load_dwordx8 s[12:19], s[32:33], s68 glc
    s_lshl_b32 s76, s60, 13
    s_add_u32 m0, s76, 99072
    s_add_u32 s78, s9, 393216
    buffer_load_dwordx4 v10, s[44:47], s78 offen offset:0 lds
    buffer_load_dwordx4 v11, s[44:47], s78 offen offset:1024 lds
    buffer_load_dwordx4 v12, s[44:47], s78 offen offset:2048 lds
    buffer_load_dwordx4 v13, s[44:47], s78 offen offset:3072 lds
    s_lshl_b32 s76, s60, 13
    s_add_u32 m0, s76, 103168
    s_add_u32 s78, s9, 425984
    buffer_load_dwordx4 v10, s[44:47], s78 offen offset:0 lds
    buffer_load_dwordx4 v11, s[44:47], s78 offen offset:1024 lds
    buffer_load_dwordx4 v12, s[44:47], s78 offen offset:2048 lds
    buffer_load_dwordx4 v13, s[44:47], s78 offen offset:3072 lds
    s_mov_b32 s77, 0
L_sretry_5:
    s_waitcnt lgkmcnt(0)
    s_xor_b32 s12, s12, s65
    s_xor_b32 s13, s13, s65
    s_xor_b32 s14, s14, s65
    s_xor_b32 s15, s15, s65
    s_xor_b32 s16, s16, s65
    s_xor_b32 s17, s17, s65
    s_xor_b32 s18, s18, s65
    s_or_b32 s12, s12, s13
    s_or_b32 s12, s12, s14
    s_or_b32 s12, s12, s15
    s_or_b32 s12, s12, s16
    s_or_b32 s12, s12, s17
    s_or_b32 s12, s12, s18
    s_cbranch_scc0 L_sok_6
    s_add_u32 s77, s77, 1
    s_cmp_ge_u32 s77, 40000
    s_cbranch_scc1 L_sok_6
    s_sleep 3
    s_load_dwordx8 s[12:19], s[32:33], s68 glc
    s_branch L_sretry_5
L_sok_6:
    buffer_load_dwordx4 v[24:27], v18, s[52:55], s10 offen offset:0 sc1
    buffer_load_dwordx4 v[28:31], v19, s[52:55], s10 offen offset:0 sc1
    buffer_load_dwordx4 v[32:35], v18, s[52:55], s10 offen offset:1024 sc1
    buffer_load_dwordx4 v[36:39], v19, s[52:55], s10 offen offset:1024 sc1
    buffer_load_dwordx4 v[40:43], v18, s[52:55], s10 offen offset:2048 sc1
    buffer_load_dwordx4 v[44:47], v19, s[52:55], s10 offen offset:2048 sc1
    buffer_load_dwordx4 v[48:51], v18, s[52:55], s10 offen offset:3072 sc1
    buffer_load_dwordx4 v[52:55], v19, s[52:55], s10 offen offset:3072 sc1
    s_add_u32 s10, s10, 4096
    buffer_load_dwordx4 v[56:59], v18, s[52:55], s10 offen offset:0 sc1
    buffer_load_dwordx4 v[60:63], v19, s[52:55], s10 offen offset:0 sc1
    s_waitcnt vmcnt(8)
    v_mfma_f32_32x32x16_bf16 v[64:79], v[224:227], v[24:27], 0
    v_mfma_f32_32x32x16_bf16 v[80:95], v[224:227], v[28:31], 0
    v_mfma_f32_32x32x16_bf16 v[96:111], v[228:231], v[24:27], 0
    v_mfma_f32_32x32x16_bf16 v[112:127], v[228:231], v[28:31], 0
    buffer_load_dwordx4 v[24:27], v18, s[52:55], s10 offen offset:1024 sc1
    buffer_load_dwordx4 v[28:31], v19, s[52:55], s10 offen offset:1024 sc1
    buffer_load_dwordx4 v[224:227], v18, s[52:55], s10 offen offset:2048 sc1
    buffer_load_dwordx4 v[228:231], v19, s[52:55], s10 offen offset:2048 sc1
    s_waitcnt vmcnt(10)
    v_mfma_f32_32x32x16_bf16 v[64:79], v[232:235], v[32:35], v[64:79]
    v_mfma_f32_32x32x16_bf16 v[80:95], v[232:235], v[36:39], v[80:95]
    v_mfma_f32_32x32x16_bf16 v[96:111], v[236:239], v[32:35], v[96:111]
    v_mfma_f32_32x32x16_bf16 v[112:127], v[236:239], v[36:39], v[112:127]
    buffer_load_dwordx4 v[32:35], v18, s[52:55], s10 offen offset:3072 sc1
    buffer_load_dwordx4 v[36:39], v19, s[52:55], s10 offen offset:3072 sc1
    s_add_u32 s10, s10, 4096
    buffer_load_dwordx4 v[232:235], v18, s[52:55], s10 offen offset:0 sc1
    buffer_load_dwordx4 v[236:239], v19, s[52:55], s10 offen offset:0 sc1
    s_waitcnt vmcnt(12)
    v_mfma_f32_32x32x16_bf16 v[64:79], v[240:243], v[40:43], v[64:79]
    v_mfma_f32_32x32x16_bf16 v[80:95], v[240:243], v[44:47], v[80:95]
    v_mfma_f32_32x32x16_bf16 v[96:111], v[244:247], v[40:43], v[96:111]
    v_mfma_f32_32x32x16_bf16 v[112:127], v[244:247], v[44:47], v[112:127]
    buffer_load_dwordx4 v[40:43], v18, s[52:55], s10 offen offset:1024 sc1
    buffer_load_dwordx4 v[44:47], v19, s[52:55], s10 offen offset:1024 sc1
    buffer_load_dwordx4 v[240:243], v18, s[52:55], s10 offen offset:2048 sc1
    buffer_load_dwordx4 v[244:247], v19, s[52:55], s10 offen offset:2048 sc1
    s_waitcnt vmcnt(14)
    v_mfma_f32_32x32x16_bf16 v[64:79], v[248:251], v[48:51], v[64:79]
    v_mfma_f32_32x32x16_bf16 v[80:95], v[248:251], v[52:55], v[80:95]
    v_mfma_f32_32x32x16_bf16 v[96:111], v[252:255], v[48:51], v[96:111]
    v_mfma_f32_32x32x16_bf16 v[112:127], v[252:255], v[52:55], v[112:127]
    buffer_load_dwordx4 v[48:51], v18, s[52:55], s10 offen offset:3072 sc1
    buffer_load_dwordx4 v[52:55], v19, s[52:55], s10 offen offset:3072 sc1
    s_add_u32 s10, s10, 4096
    buffer_load_dwordx4 v[248:251], v18, s[52:55], s10 offen offset:0 sc1
    buffer_load_dwordx4 v[252:255], v19, s[52:55], s10 offen offset:0 sc1
    s_waitcnt vmcnt(16)
    v_mfma_f32_32x32x16_bf16 v[64:79], v[128:131], v[56:59], v[64:79]
    v_mfma_f32_32x32x16_bf16 v[80:95], v[128:131], v[60:63], v[80:95]
    v_mfma_f32_32x32x16_bf16 v[96:111], v[132:135], v[56:59], v[96:111]
    v_mfma_f32_32x32x16_bf16 v[112:127], v[132:135], v[60:63], v[112:127]
    buffer_load_dwordx4 v[56:59], v18, s[52:55], s10 offen offset:1024 sc1
    buffer_load_dwordx4 v[60:63], v19, s[52:55], s10 offen offset:1024 sc1
    s_waitcnt vmcnt(16)
    v_mfma_f32_32x32x16_bf16 v[64:79], v[136:139], v[24:27], v[64:79]
    v_mfma_f32_32x32x16_bf16 v[80:95], v[136:139], v[28:31], v[80:95]
    v_mfma_f32_32x32x16_bf16 v[96:111], v[140:143], v[24:27], v[96:111]
    v_mfma_f32_32x32x16_bf16 v[112:127], v[140:143], v[28:31], v[112:127]
    buffer_load_dwordx4 v[128:131], v18, s[52:55], s10 offen offset:2048 sc1
    buffer_load_dwordx4 v[132:135], v19, s[52:55], s10 offen offset:2048 sc1
    s_waitcnt vmcnt(16)
    v_mfma_f32_32x32x16_bf16 v[64:79], v[144:147], v[224:227], v[64:79]
    v_mfma_f32_32x32x16_bf16 v[80:95], v[144:147], v[228:231], v[80:95]
    v_mfma_f32_32x32x16_bf16 v[96:111], v[148:151], v[224:227], v[96:111]
    v_mfma_f32_32x32x16_bf16 v[112:127], v[148:151], v[228:231], v[112:127]
    buffer_load_dwordx4 v[24:27], v18, s[52:55], s10 offen offset:3072 sc1
    buffer_load_dwordx4 v[28:31], v19, s[52:55], s10 offen offset:3072 sc1
    s_waitcnt vmcnt(16)
    v_mfma_f32_32x32x16_bf16 v[64:79], v[152:155], v[32:35], v[64:79]
    v_mfma_f32_32x32x16_bf16 v[80:95], v[152:155], v[36:39], v[80:95]
    v_mfma_f32_32x32x16_bf16 v[96:111], v[156:159], v[32:35], v[96:111]
    v_mfma_f32_32x32x16_bf16 v[112:127], v[156:159], v[36:39], v[112:127]
    s_add_u32 s10, s10, 4096
    buffer_load_dwordx4 v[136:139], v18, s[52:55], s10 offen offset:0 sc1
    buffer_load_dwordx4 v[140:143], v19, s[52:55], s10 offen offset:0 sc1
    s_waitcnt vmcnt(16)
    v_mfma_f32_32x32x16_bf16 v[64:79], v[160:163], v[232:235], v[64:79]
    v_mfma_f32_32x32x16_bf16 v[80:95], v[160:163], v[236:239], v[80:95]
    v_mfma_f32_32x32x16_bf16 v[96:111], v[164:167], v[232:235], v[96:111]
    v_mfma_f32_32x32x16_bf16 v[112:127], v[164:167], v[236:239], v[112:127]
    buffer_load_dwordx4 v[144:147], v18, s[52:55], s10 offen offset:1024 sc1
    buffer_load_dwordx4 v[148:151], v19, s[52:55], s10 offen offset:1024 sc1
    s_waitcnt vmcnt(16)
    v_mfma_f32_32x32x16_bf16 v[64:79], v[168:171], v[40:43], v[64:79]
    v_mfma_f32_32x32x16_bf16 v[80:95], v[168:171], v[44:47], v[80:95]
    v_mfma_f32_32x32x16_bf16 v[96:111], v[172:175], v[40:43], v[96:111]
    v_mfma_f32_32x32x16_bf16 v[112:127], v[172:175], v[44:47], v[112:127]
    buffer_load_dwordx4 v[32:35], v18, s[52:55], s10 offen offset:2048 sc1
    buffer_load_dwordx4 v[36:39], v19, s[52:55], s10 offen offset:2048 sc1
    s_waitcnt vmcnt(16)
    v_mfma_f32_32x32x16_bf16 v[64:79], v[176:179], v[240:243], v[64:79]
    v_mfma_f32_32x32x16_bf16 v[80:95], v[176:179], v[244:247], v[80:95]
    v_mfma_f32_32x32x16_bf16 v[96:111], v[180:183], v[240:243], v[96:111]
    v_mfma_f32_32x32x16_bf16 v[112:127], v[180:183], v[244:247], v[112:127]
    buffer_load_dwordx4 v[40:43], v18, s[52:55], s10 offen offset:3072 sc1
    buffer_load_dwordx4 v[44:47], v19, s[52:55], s10 offen offset:3072 sc1
    s_waitcnt vmcnt(16)
    v_mfma_f32_32x32x16_bf16 v[64:79], v[184:187], v[48:51], v[64:79]
    v_mfma_f32_32x32x16_bf16 v[80:95], v[184:187], v[52:55], v[80:95]
    v_mfma_f32_32x32x16_bf16 v[96:111], v[188:191], v[48:51], v[96:111]
    v_mfma_f32_32x32x16_bf16 v[112:127], v[188:191], v[52:55], v[112:127]
    s_add_u32 s10, s10, 4096
    buffer_load_dwordx4 v[240:243], v18, s[52:55], s10 offen offset:0 sc1
    buffer_load_dwordx4 v[244:247], v19, s[52:55], s10 offen offset:0 sc1
    s_waitcnt vmcnt(16)
    v_mfma_f32_32x32x16_bf16 v[64:79], v[192:195], v[248:251], v[64:79]
    v_mfma_f32_32x32x16_bf16 v[80:95], v[192:195], v[252:255], v[80:95]
    v_mfma_f32_32x32x16_bf16 v[96:111], v[196:199], v[248:251], v[96:111]
    v_mfma_f32_32x32x16_bf16 v[112:127], v[196:199], v[252:255], v[112:127]
    buffer_load_dwordx4 v[176:179], v18, s[52:55], s10 offen offset:1024 sc1
    buffer_load_dwordx4 v[180:183], v19, s[52:55], s10 offen offset:1024 sc1
    s_waitcnt vmcnt(16)
    v_mfma_f32_32x32x16_bf16 v[64:79], v[200:203], v[56:59], v[64:79]
    v_mfma_f32_32x32x16_bf16 v[80:95], v[200:203], v[60:63], v[80:95]
    v_mfma_f32_32x32x16_bf16 v[96:111], v[204:207], v[56:59], v[96:111]
    v_mfma_f32_32x32x16_bf16 v[112:127], v[204:207], v[60:63], v[112:127]
    v_mov_b32 v2, 136956
    v_mov_b32 v3, 1
    s_mov_b64 exec, 1
    ds_write_b32 v2, v3
    s_mov_b64 exec, -1
    buffer_load_dwordx4 v[48:51], v18, s[52:55], s10 offen offset:2048 sc1
    buffer_load_dwordx4 v[52:55], v19, s[52:55], s10 offen offset:2048 sc1
    s_waitcnt vmcnt(16)
    v_mfma_f32_32x32x16_bf16 v[64:79], v[208:211], v[128:131], v[64:79]
    v_mfma_f32_32x32x16_bf16 v[80:95], v[208:211], v[132:135], v[80:95]
    v_mfma_f32_32x32x16_bf16 v[96:111], v[212:215], v[128:131], v[96:111]
    v_mfma_f32_32x32x16_bf16 v[112:127], v[212:215], v[132:135], v[112:127]
    buffer_load_dwordx4 v[184:187], v18, s[52:55], s10 offen offset:3072 sc1
    buffer_load_dwordx4 v[188:191], v19, s[52:55], s10 offen offset:3072 sc1
    s_waitcnt vmcnt(16)
    v_mfma_f32_32x32x16_bf16 v[64:79], v[216:219], v[24:27], v[64:79]
    ds_read_b64_tr_b16 v[224:225], v16 offset:0
    ds_read_b64_tr_b16 v[226:227], v16 offset:1024
    v_mfma_f32_32x32x16_bf16 v[80:95], v[216:219], v[28:31], v[80:95]
    ds_read_b64_tr_b16 v[228:229], v17 offset:0
    ds_read_b64_tr_b16 v[230:231], v17 offset:1024
    v_mfma_f32_32x32x16_bf16 v[96:111], v[220:223], v[24:27], v[96:111]
    v_mfma_f32_32x32x16_bf16 v[112:127], v[220:223], v[28:31], v[112:127]
    s_add_u32 s10, s10, 4096
    buffer_load_dwordx4 v[248:251], v18, s[52:55], s10 offen offset:0 sc1
    buffer_load_dwordx4 v[252:255], v19, s[52:55], s10 offen offset:0 sc1
    s_waitcnt vmcnt(16)
    s_waitcnt lgkmcnt(2)
    v_mfma_f32_32x32x16_bf16 v[64:79], v[224:227], v[136:139], v[64:79]
    ds_read_b64_tr_b16 v[232:233], v16 offset:2048
    ds_read_b64_tr_b16 v[234:235], v16 offset:3072
    v_mfma_f32_32x32x16_bf16 v[80:95], v[224:227], v[140:143], v[80:95]
    ds_read_b64_tr_b16 v[236:237], v17 offset:2048
    ds_read_b64_tr_b16 v[238:239], v17 offset:3072
    s_waitcnt lgkmcnt(4)
    v_mfma_f32_32x32x16_bf16 v[96:111], v[228:231], v[136:139], v[96:111]
    v_mfma_f32_32x32x16_bf16 v[112:127], v[228:231], v[140:143], v[112:127]
    buffer_load_dwordx4 v[192:195], v18, s[52:55], s10 offen offset:1024 sc1
    buffer_load_dwordx4 v[196:199], v19, s[52:55], s10 offen offset:1024 sc1
    s_waitcnt vmcnt(16)
    s_waitcnt lgkmcnt(2)
    v_mfma_f32_32x32x16_bf16 v[64:79], v[232:235], v[144:147], v[64:79]
    ds_read_b64_tr_b16 v[224:225], v16 offset:4096
    ds_read_b64_tr_b16 v[226:227], v16 offset:5120
    v_mfma_f32_32x32x16_bf16 v[80:95], v[232:235], v[148:151], v[80:95]
    ds_read_b64_tr_b16 v[228:229], v17 offset:4096
    ds_read_b64_tr_b16 v[230:231], v17 offset:5120
    s_waitcnt lgkmcnt(4)
    v_mfma_f32_32x32x16_bf16 v[96:111], v[236:239], v[144:147], v[96:111]
    v_mfma_f32_32x32x16_bf16 v[112:127], v[236:239], v[148:151], v[112:127]
    buffer_load_dwordx4 v[56:59], v18, s[52:55], s10 offen offset:2048 sc1
    buffer_load_dwordx4 v[60:63], v19, s[52:55], s10 offen offset:2048 sc1
    s_waitcnt vmcnt(16)
    s_waitcnt lgkmcnt(2)
    v_mfma_f32_32x32x16_bf16 v[64:79], v[224:227], v[32:35], v[64:79]
    ds_read_b64_tr_b16 v[232:233], v16 offset:6144
    ds_read_b64_tr_b16 v[234:235], v16 offset:7168
    v_mfma_f32_32x32x16_bf16 v[80:95], v[224:227], v[36:39], v[80:95]
    ds_read_b64_tr_b16 v[236:237], v17 offset:6144
    ds_read_b64_tr_b16 v[238:239], v17 offset:7168
    s_waitcnt lgkmcnt(4)
    v_mfma_f32_32x32x16_bf16 v[96:111], v[228:231], v[32:35], v[96:111]
    v_mfma_f32_32x32x16_bf16 v[112:127], v[228:231], v[36:39], v[112:127]
    buffer_load_dwordx4 v[200:203], v18, s[52:55], s10 offen offset:3072 sc1
    buffer_load_dwordx4 v[204:207], v19, s[52:55], s10 offen offset:3072 sc1
    s_waitcnt vmcnt(16)
    s_waitcnt lgkmcnt(2)
    v_mfma_f32_32x32x16_bf16 v[64:79], v[232:235], v[40:43], v[64:79]
    ds_read_b64_tr_b16 v[224:225], v14 offset:0
    ds_read_b64_tr_b16 v[226:227], v14 offset:1024
    v_mfma_f32_32x32x16_bf16 v[80:95], v[232:235], v[44:47], v[80:95]
    ds_read_b64_tr_b16 v[228:229], v15 offset:0
    ds_read_b64_tr_b16 v[230:231], v15 offset:1024
    s_waitcnt lgkmcnt(4)
    v_mfma_f32_32x32x16_bf16 v[96:111], v[236:239], v[40:43], v[96:111]
    v_mfma_f32_32x32x16_bf16 v[112:127], v[236:239], v[44:47], v[112:127]
    s_waitcnt vmcnt(14)
    s_waitcnt lgkmcnt(2)
    v_mfma_f32_32x32x16_bf16 v[64:79], v[224:227], v[240:243], v[64:79]
    ds_read_b64_tr_b16 v[232:233], v14 offset:2048
    ds_read_b64_tr_b16 v[234:235], v14 offset:3072
    v_mfma_f32_32x32x16_bf16 v[80:95], v[224:227], v[244:247], v[80:95]
    ds_read_b64_tr_b16 v[236:237], v15 offset:2048
    ds_read_b64_tr_b16 v[238:239], v15 offset:3072
    s_waitcnt lgkmcnt(4)
    v_mfma_f32_32x32x16_bf16 v[96:111], v[228:231], v[240:243], v[96:111]
    ds_read_b64_tr_b16 v[168:169], v16 offset:33024
    ds_read_b64_tr_b16 v[170:171], v16 offset:34048
    v_mfma_f32_32x32x16_bf16 v[112:127], v[228:231], v[244:247], v[112:127]
    ds_read_b64_tr_b16 v[172:173], v17 offset:33024
    ds_read_b64_tr_b16 v[174:175], v17 offset:34048
    v_and_b32 v2, 31, v1
    v_lshrrev_b32 v3, 5, v1
    v_and_b32 v4, 15, v1
    v_xor_b32 v3, v3, v4
    v_lshlrev_b32 v3, 4, v3
    v_lshl_add_u32 v3, v2, 8, v3
    s_lshl_b32 s76, s60, 13
    v_add_u32 v128, s76, v3
    v_xor_b32 v129, 32, v128
    v_xor_b32 v130, 64, v128
    v_xor_b32 v131, 96, v128
    v_xor_b32 v132, 128, v128
    v_xor_b32 v133, 160, v128
    v_xor_b32 v134, 192, v128
    v_xor_b32 v135, 224, v128
    v_add_u32 v136, 66048, v128
    v_add_u32 v137, 66048, v129
    v_add_u32 v138, 66048, v130
    v_add_u32 v139, 66048, v131
    v_add_u32 v140, 66048, v132
    v_add_u32 v141, 66048, v133
    v_add_u32 v142, 66048, v134
    v_add_u32 v143, 66048, v135
    s_waitcnt vmcnt(12)
    s_waitcnt lgkmcnt(6)
    v_mfma_f32_32x32x16_bf16 v[64:79], v[232:235], v[176:179], v[64:79]
    ds_read_b64_tr_b16 v[224:225], v14 offset:4096
    ds_read_b64_tr_b16 v[226:227], v14 offset:5120
    v_mfma_f32_32x32x16_bf16 v[80:95], v[232:235], v[180:183], v[80:95]
    ds_read_b64_tr_b16 v[228:229], v15 offset:4096
    ds_read_b64_tr_b16 v[230:231], v15 offset:5120
    s_waitcnt lgkmcnt(8)
    v_mfma_f32_32x32x16_bf16 v[96:111], v[236:239], v[176:179], v[96:111]
    ds_read_b64_tr_b16 v[160:161], v16 offset:35072
    ds_read_b64_tr_b16 v[162:163], v16 offset:36096
    v_mfma_f32_32x32x16_bf16 v[112:127], v[236:239], v[180:183], v[112:127]
    ds_read_b64_tr_b16 v[164:165], v17 offset:35072
    ds_read_b64_tr_b16 v[166:167], v17 offset:36096
    v_lshrrev_b32 v5, 3, v1
    v_and_b32 v6, 7, v1
    v_add_u32 v5, 8, v5
    v_lshlrev_b32 v6, 1, v6
    v_xor_b32 v6, v6, v5
    v_lshlrev_b32 v6, 4, v6
    v_lshl_add_u32 v6, v5, 8, v6
    s_and_b32 s73, s60, 1
    s_lshl_b32 s73, s73, 12
    s_cmp_ge_u32 s60, 2
    s_cselect_b32 s74, 66048, 0
    s_add_u32 s73, s73, s74
    v_add_u32 v10, s73, v6
    v_xor_b32 v11, 16, v10
    s_mul_i32 s73, s60, 2304
    s_add_u32 s73, s73, 137984
    v_lshl_add_u32 v12, v1, 4, s73
    v_lshl_add_u32 v13, v1, 2, s73
    v_lshrrev_b32 v2, 3, v1
    v_and_b32 v3, 7, v1
    v_lshlrev_b32 v2, 10, v2
    v_lshl_add_u32 v20, v3, 4, v2
    s_lshl2_add_u32 s74, s66, s60
    s_lshl_b32 s74, s74, 14
    s_lshl_b32 s73, s67, 7
    s_add_u32 s74, s74, s73
    s_add_u32 s78, s74, 8192
    s_waitcnt vmcnt(10)
    s_waitcnt lgkmcnt(6)
    v_mfma_f32_32x32x16_bf16 v[64:79], v[224:227], v[48:51], v[64:79]
    ds_read_b64_tr_b16 v[232:233], v14 offset:6144
    ds_read_b64_tr_b16 v[234:235], v14 offset:7168
    v_mfma_f32_32x32x16_bf16 v[80:95], v[224:227], v[52:55], v[80:95]
    ds_read_b64_tr_b16 v[236:237], v15 offset:6144
    ds_read_b64_tr_b16 v[238:239], v15 offset:7168
    s_waitcnt lgkmcnt(8)
    v_mfma_f32_32x32x16_bf16 v[96:111], v[228:231], v[48:51], v[96:111]
    ds_read_b64_tr_b16 v[152:153], v16 offset:37120
    ds_read_b64_tr_b16 v[154:155], v16 offset:38144
    v_mfma_f32_32x32x16_bf16 v[112:127], v[228:231], v[52:55], v[112:127]
    ds_read_b64_tr_b16 v[156:157], v17 offset:37120
    ds_read_b64_tr_b16 v[158:159], v17 offset:38144
    s_waitcnt vmcnt(8)
    s_waitcnt lgkmcnt(6)
    v_mfma_f32_32x32x16_bf16 v[64:79], v[232:235], v[184:187], v[64:79]
    ds_read_b64_tr_b16 v[144:145], v16 offset:39168
    ds_read_b64_tr_b16 v[146:147], v16 offset:40192
    v_mfma_f32_32x32x16_bf16 v[80:95], v[232:235], v[188:191], v[80:95]
    ds_read_b64_tr_b16 v[148:149], v17 offset:39168
    ds_read_b64_tr_b16 v[150:151], v17 offset:40192
    s_waitcnt lgkmcnt(8)
    v_mfma_f32_32x32x16_bf16 v[96:111], v[236:239], v[184:187], v[96:111]
    v_mfma_f32_32x32x16_bf16 v[112:127], v[236:239], v[188:191], v[112:127]
    s_waitcnt vmcnt(6)
    v_mfma_f32_32x32x16_bf16 v[64:79], v[168:171], v[248:251], v[64:79]
    s_waitcnt vmcnt(4)
    v_mfma_f32_32x32x16_bf16 v[64:79], v[160:163], v[192:195], v[64:79]
    s_waitcnt vmcnt(2)
    s_waitcnt lgkmcnt(6)
    v_mfma_f32_32x32x16_bf16 v[64:79], v[152:155], v[56:59], v[64:79]
    s_waitcnt vmcnt(0)
    s_waitcnt lgkmcnt(2)
    v_mfma_f32_32x32x16_bf16 v[64:79], v[144:147], v[200:203], v[64:79]
    v_mfma_f32_32x32x16_bf16 v[80:95], v[168:171], v[252:255], v[80:95]
    v_mfma_f32_32x32x16_bf16 v[80:95], v[160:163], v[196:199], v[80:95]
    v_mfma_f32_32x32x16_bf16 v[80:95], v[152:155], v[60:63], v[80:95]
    v_mfma_f32_32x32x16_bf16 v[80:95], v[144:147], v[204:207], v[80:95]
    v_mfma_f32_32x32x16_bf16 v[96:111], v[172:175], v[248:251], v[96:111]
    s_nop 6
    ds_write_b128 v128, v[64:67]
    v_mfma_f32_32x32x16_bf16 v[96:111], v[164:167], v[192:195], v[96:111]
    ds_write_b128 v129, v[68:71]
    v_mfma_f32_32x32x16_bf16 v[96:111], v[156:159], v[56:59], v[96:111]
    ds_write_b128 v130, v[72:75]
    s_waitcnt lgkmcnt(3)
    v_mfma_f32_32x32x16_bf16 v[96:111], v[148:151], v[200:203], v[96:111]
    ds_write_b128 v131, v[76:79]
    v_mfma_f32_32x32x16_bf16 v[112:127], v[172:175], v[252:255], v[112:127]
    ds_write_b128 v136, v[80:83]
    v_mfma_f32_32x32x16_bf16 v[112:127], v[164:167], v[196:199], v[112:127]
    ds_write_b128 v137, v[84:87]
    v_mfma_f32_32x32x16_bf16 v[112:127], v[156:159], v[60:63], v[112:127]
    ds_write_b128 v138, v[88:91]
    v_mfma_f32_32x32x16_bf16 v[112:127], v[148:151], v[204:207], v[112:127]
    ds_write_b128 v139, v[92:95]
    s_nop 2
    ds_write_b128 v132, v[96:99]
    ds_write_b128 v133, v[100:103]
    ds_write_b128 v134, v[104:107]
    ds_write_b128 v135, v[108:111]
    s_nop 3
    ds_write_b128 v140, v[112:115]
    ds_write_b128 v141, v[116:119]
    ds_write_b128 v142, v[120:123]
    ds_write_b128 v143, v[124:127]
    s_waitcnt lgkmcnt(0)
    s_barrier
    ds_read_b128 v[64:67], v10 offset:0
    ds_read_b128 v[68:71], v11 offset:0
    ds_read_b128 v[72:75], v10 offset:8192
    ds_read_b128 v[76:79], v11 offset:8192
    ds_read_b128 v[104:107], v12 offset:0
    ds_read_b128 v[108:111], v12 offset:1024
    ds_read_b32 v112, v13 offset:2048
    ds_read_b128 v[80:83], v10 offset:16384
    ds_read_b128 v[84:87], v11 offset:16384
    ds_read_b128 v[88:91], v10 offset:24576
    ds_read_b128 v[92:95], v11 offset:24576
    s_waitcnt lgkmcnt(7)
    v_pk_add_f32 v[64:65], v[64:65], v[72:73]
    v_pk_add_f32 v[66:67], v[66:67], v[74:75]
    v_pk_add_f32 v[68:69], v[68:69], v[76:77]
    v_pk_add_f32 v[70:71], v[70:71], v[78:79]
    s_waitcnt lgkmcnt(2)
    v_pk_add_f32 v[64:65], v[64:65], v[80:81]
    v_pk_add_f32 v[66:67], v[66:67], v[82:83]
    v_pk_add_f32 v[68:69], v[68:69], v[84:85]
    v_pk_add_f32 v[70:71], v[70:71], v[86:87]
    s_waitcnt lgkmcnt(0)
    v_pk_add_f32 v[64:65], v[64:65], v[88:89]
    v_pk_add_f32 v[66:67], v[66:67], v[90:91]
    v_pk_add_f32 v[68:69], v[68:69], v[92:93]
    v_pk_add_f32 v[70:71], v[70:71], v[94:95]
    v_pk_fma_f32 v[104:105], v[64:65], v[112:113], v[104:105] op_sel_hi:[1,0,1]
    v_pk_fma_f32 v[106:107], v[66:67], v[112:113], v[106:107] op_sel_hi:[1,0,1]
    v_pk_fma_f32 v[108:109], v[68:69], v[112:113], v[108:109] op_sel_hi:[1,0,1]
    v_pk_fma_f32 v[110:111], v[70:71], v[112:113], v[110:111] op_sel_hi:[1,0,1]
    v_cvt_pk_bf16_f32 v72, v104, v105
    v_cvt_pk_bf16_f32 v73, v106, v107
    v_cvt_pk_bf16_f32 v74, v108, v109
    v_cvt_pk_bf16_f32 v75, v110, v111
    buffer_store_dwordx4 v[72:75], v20, s[48:51], s78 offen sc1
    s_endpgm
L_SPARE0:
    v_lshlrev_b32 v24, 4, v1
    s_lshl_b32 s73, s61, 1
    s_add_u32 s73, s73, s63
    s_mov_b32 s62, s73
    s_lshl_b32 s73, s73, 16
    s_lshl_b32 s74, s60, 14
    s_add_u32 s73, s73, s74
    s_mul_i32 s74, s60, 16640
    s_add_u32 m0, s74, 0
    s_add_u32 s75, s73, 0
    buffer_load_dwordx4 v24, s[36:39], s75 offen lds
    s_add_u32 m0, s74, 1040
    s_add_u32 s75, s73, 1024
    buffer_load_dwordx4 v24, s[36:39], s75 offen lds
    s_add_u32 m0, s74, 2080
    s_add_u32 s75, s73, 2048
    buffer_load_dwordx4 v24, s[36:39], s75 offen lds
    s_add_u32 m0, s74, 3120
    s_add_u32 s75, s73, 3072
    buffer_load_dwordx4 v24, s[36:39], s75 offen lds
    s_add_u32 m0, s74, 4160
    s_add_u32 s75, s73, 4096
    buffer_load_dwordx4 v24, s[36:39], s75 offen lds
    s_add_u32 m0, s74, 5200
    s_add_u32 s75, s73, 5120
    buffer_load_dwordx4 v24, s[36:39], s75 offen lds
    s_add_u32 m0, s74, 6240
    s_add_u32 s75, s73, 6144
    buffer_load_dwordx4 v24, s[36:39], s75 offen lds
    s_add_u32 m0, s74, 7280
    s_add_u32 s75, s73, 7168
    buffer_load_dwordx4 v24, s[36:39], s75 offen lds
    s_add_u32 m0, s74, 8320
    s_add_u32 s75, s73, 8192
    buffer_load_dwordx4 v24, s[36:39], s75 offen lds
    s_add_u32 m0, s74, 9360
    s_add_u32 s75, s73, 9216
    buffer_load_dwordx4 v24, s[36:39], s75 offen lds
    s_add_u32 m0, s74, 10400
    s_add_u32 s75, s73, 10240
    buffer_load_dwordx4 v24, s[36:39], s75 offen lds
    s_add_u32 m0, s74, 11440
    s_add_u32 s75, s73, 11264
    buffer_load_dwordx4 v24, s[36:39], s75 offen lds
    s_add_u32 m0, s74, 12480
    s_add_u32 s75, s73, 12288
    buffer_load_dwordx4 v24, s[36:39], s75 offen lds
    s_add_u32 m0, s74, 13520
    s_add_u32 s75, s73, 13312
    buffer_load_dwordx4 v24, s[36:39], s75 offen lds
    s_add_u32 m0, s74, 14560
    s_add_u32 s75, s73, 14336
    buffer_load_dwordx4 v24, s[36:39], s75 offen lds
    s_add_u32 m0, s74, 15600
    s_add_u32 s75, s73, 15360
    buffer_load_dwordx4 v24, s[36:39], s75 offen lds
    s_mov_b32 s52, s32
    s_mov_b32 s53, s33
    s_mov_b32 s54, 0xb40000
    s_mov_b32 s55, 0x20000
    s_mov_b32 s56, s30
    s_mov_b32 s57, s31
    s_mov_b32 s58, 0x100
    s_mov_b32 s59, 0x20000
    s_mov_b32 s44, s26
    s_mov_b32 s45, s27
    s_mov_b32 s46, 0x1c0000
    s_mov_b32 s47, 0x20000
    s_mov_b32 s48, s28
    s_mov_b32 s49, s29
    s_mov_b32 s50, 0x200000
    s_mov_b32 s51, 0x20000
    v_lshrrev_b32 v2, 3, v1
    v_and_b32 v3, 7, v1
    v_bfe_u32 v4, v1, 4, 1
    v_lshlrev_b32 v4, 2, v4
    v_xor_b32 v3, v3, v4
    v_lshlrev_b32 v3, 4, v3
    v_lshl_add_u32 v10, v2, 10, v3
    v_add_u32 v11, 7168, v10
    v_add_u32 v12, 14336, v10
    v_add_u32 v13, 21504, v10
    s_mul_i32 s76, s60, 28
    s_lshl_b32 s9, s76, 14
    s_lshl_b32 s78, s67, 7
    s_add_u32 s9, s9, s78
    s_mul_i32 s10, s66, 224
    s_add_u32 s10, s10, s76
    s_lshl_b32 s10, s10, 10
    v_bfe_u32 v2, v1, 2, 2
    v_lshrrev_b32 v3, 5, v1
    v_lshl_add_u32 v3, v3, 2, v2
    v_lshlrev_b32 v3, 7, v3
    v_lshrrev_b32 v2, 1, v2
    v_lshl_add_u32 v3, v2, 6, v3
    v_bfe_u32 v2, v1, 4, 1
    v_lshl_add_u32 v3, v2, 5, v3
    v_and_b32 v2, 3, v1
    v_lshl_add_u32 v3, v2, 3, v3
    s_lshl_b32 s76, s60, 13
    v_add_u32 v14, s76, v3
    v_xor_b32 v15, 64, v14
    v_add_u32 v16, 66048, v14
    v_add_u32 v17, 66048, v15
    v_lshlrev_b32 v18, 4, v1
    v_add_u32 v19, 114688, v18
    v_and_b32 v2, 15, v1
    v_lshrrev_b32 v3, 4, v1
    v_lshl_add_u32 v4, v2, 2, v3
    v_mul_u32_u24 v5, 1040, v4
    s_lshl_b32 s75, s60, 8
    v_add_u32 v5, s75, v5
    v_mov_b32 v44, 0
    v_mov_b32 v45, 0
    s_mov_b32 s72, 0x3f803f80
    s_waitcnt vmcnt(0) lgkmcnt(0)
    s_barrier
    buffer_load_dword v20, off, s[56:59], 0 sc1
    ds_read_b128 v[64:67], v5 offset:0
    ds_read_b128 v[68:71], v5 offset:16
    ds_read_b128 v[72:75], v5 offset:32
    ds_read_b128 v[76:79], v5 offset:48
    ds_read_b128 v[80:83], v5 offset:64
    ds_read_b128 v[84:87], v5 offset:80
    ds_read_b128 v[88:91], v5 offset:96
    ds_read_b128 v[92:95], v5 offset:112
    ds_read_b128 v[96:99], v5 offset:128
    ds_read_b128 v[100:103], v5 offset:144
    ds_read_b128 v[104:107], v5 offset:160
    ds_read_b128 v[108:111], v5 offset:176
    ds_read_b128 v[112:115], v5 offset:192
    ds_read_b128 v[116:119], v5 offset:208
    ds_read_b128 v[120:123], v5 offset:224
    ds_read_b128 v[124:127], v5 offset:240
    v_lshlrev_b32 v3, 13, v3
    v_lshl_add_u32 v3, v2, 4, v3
    s_lshl_b32 s73, s60, 19
    s_lshl_b32 s74, s62, 8
    s_add_u32 s73, s73, s74
    s_add_u32 s73, s73, 0x700000
    s_waitcnt lgkmcnt(15)
    v_dot2_f32_bf16 v44, v64, s72, v44
    v_dot2_f32_bf16 v45, v64, v64, v45
    v_dot2_f32_bf16 v44, v65, s72, v44
    v_dot2_f32_bf16 v45, v65, v65, v45
    v_dot2_f32_bf16 v44, v66, s72, v44
    v_dot2_f32_bf16 v45, v66, v66, v45
    v_dot2_f32_bf16 v44, v67, s72, v44
    v_dot2_f32_bf16 v45, v67, v67, v45
    v_permlane32_swap_b32 v64, v66
    v_permlane32_swap_b32 v65, v67
    s_nop 1
    v_permlane16_swap_b32 v64, v65
    v_permlane16_swap_b32 v66, v67
    buffer_store_dwordx4 v[64:67], v3, s[52:55], s73 offen sc1
    s_waitcnt lgkmcnt(14)
    v_dot2_f32_bf16 v44, v68, s72, v44
    v_dot2_f32_bf16 v45, v68, v68, v45
    v_dot2_f32_bf16 v44, v69, s72, v44
    v_dot2_f32_bf16 v45, v69, v69, v45
    v_dot2_f32_bf16 v44, v70, s72, v44
    v_dot2_f32_bf16 v45, v70, v70, v45
    v_dot2_f32_bf16 v44, v71, s72, v44
    v_dot2_f32_bf16 v45, v71, v71, v45
    v_permlane32_swap_b32 v68, v70
    v_permlane32_swap_b32 v69, v71
    s_add_u32 s73, s73, 32768
    s_nop 0
    v_permlane16_swap_b32 v68, v69
    v_permlane16_swap_b32 v70, v71
    buffer_store_dwordx4 v[68:71], v3, s[52:55], s73 offen sc1
    s_waitcnt lgkmcnt(13)
    v_dot2_f32_bf16 v44, v72, s72, v44
    v_dot2_f32_bf16 v45, v72, v72, v45
    v_dot2_f32_bf16 v44, v73, s72, v44
    v_dot2_f32_bf16 v45, v73, v73, v45
    v_dot2_f32_bf16 v44, v74, s72, v44
    v_dot2_f32_bf16 v45, v74, v74, v45
    v_dot2_f32_bf16 v44, v75, s72, v44
    v_dot2_f32_bf16 v45, v75, v75, v45
    v_permlane32_swap_b32 v72, v74
    v_permlane32_swap_b32 v73, v75
    s_add_u32 s73, s73, 32768
    s_nop 0
    v_permlane16_swap_b32 v72, v73
    v_permlane16_swap_b32 v74, v75
    buffer_store_dwordx4 v[72:75], v3, s[52:55], s73 offen sc1
    s_waitcnt lgkmcnt(12)
    v_dot2_f32_bf16 v44, v76, s72, v44
    v_dot2_f32_bf16 v45, v76, v76, v45
    v_dot2_f32_bf16 v44, v77, s72, v44
    v_dot2_f32_bf16 v45, v77, v77, v45
    v_dot2_f32_bf16 v44, v78, s72, v44
    v_dot2_f32_bf16 v45, v78, v78, v45
    v_dot2_f32_bf16 v44, v79, s72, v44
    v_dot2_f32_bf16 v45, v79, v79, v45
    v_permlane32_swap_b32 v76, v78
    v_permlane32_swap_b32 v77, v79
    s_add_u32 s73, s73, 32768
    s_nop 0
    v_permlane16_swap_b32 v76, v77
    v_permlane16_swap_b32 v78, v79
    buffer_store_dwordx4 v[76:79], v3, s[52:55], s73 offen sc1
    s_waitcnt lgkmcnt(11)
    v_dot2_f32_bf16 v44, v80, s72, v44
    v_dot2_f32_bf16 v45, v80, v80, v45
    v_dot2_f32_bf16 v44, v81, s72, v44
    v_dot2_f32_bf16 v45, v81, v81, v45
    v_dot2_f32_bf16 v44, v82, s72, v44
    v_dot2_f32_bf16 v45, v82, v82, v45
    v_dot2_f32_bf16 v44, v83, s72, v44
    v_dot2_f32_bf16 v45, v83, v83, v45
    v_permlane32_swap_b32 v80, v82
    v_permlane32_swap_b32 v81, v83
    s_add_u32 s73, s73, 32768
    s_nop 0
    v_permlane16_swap_b32 v80, v81
    v_permlane16_swap_b32 v82, v83
    buffer_store_dwordx4 v[80:83], v3, s[52:55], s73 offen sc1
    s_waitcnt lgkmcnt(10)
    v_dot2_f32_bf16 v44, v84, s72, v44
    v_dot2_f32_bf16 v45, v84, v84, v45
    v_dot2_f32_bf16 v44, v85, s72, v44
    v_dot2_f32_bf16 v45, v85, v85, v45
    v_dot2_f32_bf16 v44, v86, s72, v44
    v_dot2_f32_bf16 v45, v86, v86, v45
    v_dot2_f32_bf16 v44, v87, s72, v44
    v_dot2_f32_bf16 v45, v87, v87, v45
    v_permlane32_swap_b32 v84, v86
    v_permlane32_swap_b32 v85, v87
    s_add_u32 s73, s73, 32768
    s_nop 0
    v_permlane16_swap_b32 v84, v85
    v_permlane16_swap_b32 v86, v87
    buffer_store_dwordx4 v[84:87], v3, s[52:55], s73 offen sc1
    s_waitcnt lgkmcnt(9)
    v_dot2_f32_bf16 v44, v88, s72, v44
    v_dot2_f32_bf16 v45, v88, v88, v45
    v_dot2_f32_bf16 v44, v89, s72, v44
    v_dot2_f32_bf16 v45, v89, v89, v45
    v_dot2_f32_bf16 v44, v90, s72, v44
    v_dot2_f32_bf16 v45, v90, v90, v45
    v_dot2_f32_bf16 v44, v91, s72, v44
    v_dot2_f32_bf16 v45, v91, v91, v45
    v_permlane32_swap_b32 v88, v90
    v_permlane32_swap_b32 v89, v91
    s_add_u32 s73, s73, 32768
    s_nop 0
    v_permlane16_swap_b32 v88, v89
    v_permlane16_swap_b32 v90, v91
    buffer_store_dwordx4 v[88:91], v3, s[52:55], s73 offen sc1
    s_waitcnt lgkmcnt(8)
    v_dot2_f32_bf16 v44, v92, s72, v44
    v_dot2_f32_bf16 v45, v92, v92, v45
    v_dot2_f32_bf16 v44, v93, s72, v44
    v_dot2_f32_bf16 v45, v93, v93, v45
    v_dot2_f32_bf16 v44, v94, s72, v44
    v_dot2_f32_bf16 v45, v94, v94, v45
    v_dot2_f32_bf16 v44, v95, s72, v44
    v_dot2_f32_bf16 v45, v95, v95, v45
    v_permlane32_swap_b32 v92, v94
    v_permlane32_swap_b32 v93, v95
    s_add_u32 s73, s73, 32768
    s_nop 0
    v_permlane16_swap_b32 v92, v93
    v_permlane16_swap_b32 v94, v95
    buffer_store_dwordx4 v[92:95], v3, s[52:55], s73 offen sc1
    s_waitcnt lgkmcnt(7)
    v_dot2_f32_bf16 v44, v96, s72, v44
    v_dot2_f32_bf16 v45, v96, v96, v45
    v_dot2_f32_bf16 v44, v97, s72, v44
    v_dot2_f32_bf16 v45, v97, v97, v45
    v_dot2_f32_bf16 v44, v98, s72, v44
    v_dot2_f32_bf16 v45, v98, v98, v45
    v_dot2_f32_bf16 v44, v99, s72, v44
    v_dot2_f32_bf16 v45, v99, v99, v45
    v_permlane32_swap_b32 v96, v98
    v_permlane32_swap_b32 v97, v99
    s_add_u32 s73, s73, 32768
    s_nop 0
    v_permlane16_swap_b32 v96, v97
    v_permlane16_swap_b32 v98, v99
    buffer_store_dwordx4 v[96:99], v3, s[52:55], s73 offen sc1
    s_waitcnt lgkmcnt(6)
    v_dot2_f32_bf16 v44, v100, s72, v44
    v_dot2_f32_bf16 v45, v100, v100, v45
    v_dot2_f32_bf16 v44, v101, s72, v44
    v_dot2_f32_bf16 v45, v101, v101, v45
    v_dot2_f32_bf16 v44, v102, s72, v44
    v_dot2_f32_bf16 v45, v102, v102, v45
    v_dot2_f32_bf16 v44, v103, s72, v44
    v_dot2_f32_bf16 v45, v103, v103, v45
    v_permlane32_swap_b32 v100, v102
    v_permlane32_swap_b32 v101, v103
    s_add_u32 s73, s73, 32768
    s_nop 0
    v_permlane16_swap_b32 v100, v101
    v_permlane16_swap_b32 v102, v103
    buffer_store_dwordx4 v[100:103], v3, s[52:55], s73 offen sc1
    s_waitcnt lgkmcnt(5)
    v_dot2_f32_bf16 v44, v104, s72, v44
    v_dot2_f32_bf16 v45, v104, v104, v45
    v_dot2_f32_bf16 v44, v105, s72, v44
    v_dot2_f32_bf16 v45, v105, v105, v45
    v_dot2_f32_bf16 v44, v106, s72, v44
    v_dot2_f32_bf16 v45, v106, v106, v45
    v_dot2_f32_bf16 v44, v107, s72, v44
    v_dot2_f32_bf16 v45, v107, v107, v45
    v_permlane32_swap_b32 v104, v106
    v_permlane32_swap_b32 v105, v107
    s_add_u32 s73, s73, 32768
    s_nop 0
    v_permlane16_swap_b32 v104, v105
    v_permlane16_swap_b32 v106, v107
    buffer_store_dwordx4 v[104:107], v3, s[52:55], s73 offen sc1
    s_waitcnt lgkmcnt(4)
    v_dot2_f32_bf16 v44, v108, s72, v44
    v_dot2_f32_bf16 v45, v108, v108, v45
    v_dot2_f32_bf16 v44, v109, s72, v44
    v_dot2_f32_bf16 v45, v109, v109, v45
    v_dot2_f32_bf16 v44, v110, s72, v44
    v_dot2_f32_bf16 v45, v110, v110, v45
    v_dot2_f32_bf16 v44, v111, s72, v44
    v_dot2_f32_bf16 v45, v111, v111, v45
    v_permlane32_swap_b32 v108, v110
    v_permlane32_swap_b32 v109, v111
    s_add_u32 s73, s73, 32768
    s_nop 0
    v_permlane16_swap_b32 v108, v109
    v_permlane16_swap_b32 v110, v111
    buffer_store_dwordx4 v[108:111], v3, s[52:55], s73 offen sc1
    s_waitcnt lgkmcnt(3)
    v_dot2_f32_bf16 v44, v112, s72, v44
    v_dot2_f32_bf16 v45, v112, v112, v45
    v_dot2_f32_bf16 v44, v113, s72, v44
    v_dot2_f32_bf16 v45, v113, v113, v45
    v_dot2_f32_bf16 v44, v114, s72, v44
    v_dot2_f32_bf16 v45, v114, v114, v45
    v_dot2_f32_bf16 v44, v115, s72, v44
    v_dot2_f32_bf16 v45, v115, v115, v45
    v_permlane32_swap_b32 v112, v114
    v_permlane32_swap_b32 v113, v115
    s_add_u32 s73, s73, 32768
    s_nop 0
    v_permlane16_swap_b32 v112, v113
    v_permlane16_swap_b32 v114, v115
    buffer_store_dwordx4 v[112:115], v3, s[52:55], s73 offen sc1
    s_waitcnt lgkmcnt(2)
    v_dot2_f32_bf16 v44, v116, s72, v44
    v_dot2_f32_bf16 v45, v116, v116, v45
    v_dot2_f32_bf16 v44, v117, s72, v44
    v_dot2_f32_bf16 v45, v117, v117, v45
    v_dot2_f32_bf16 v44, v118, s72, v44
    v_dot2_f32_bf16 v45, v118, v118, v45
    v_dot2_f32_bf16 v44, v119, s72, v44
    v_dot2_f32_bf16 v45, v119, v119, v45
    v_permlane32_swap_b32 v116, v118
    v_permlane32_swap_b32 v117, v119
    s_add_u32 s73, s73, 32768
    s_nop 0
    v_permlane16_swap_b32 v116, v117
    v_permlane16_swap_b32 v118, v119
    buffer_store_dwordx4 v[116:119], v3, s[52:55], s73 offen sc1
    s_waitcnt lgkmcnt(1)
    v_dot2_f32_bf16 v44, v120, s72, v44
    v_dot2_f32_bf16 v45, v120, v120, v45
    v_dot2_f32_bf16 v44, v121, s72, v44
    v_dot2_f32_bf16 v45, v121, v121, v45
    v_dot2_f32_bf16 v44, v122, s72, v44
    v_dot2_f32_bf16 v45, v122, v122, v45
    v_dot2_f32_bf16 v44, v123, s72, v44
    v_dot2_f32_bf16 v45, v123, v123, v45
    v_permlane32_swap_b32 v120, v122
    v_permlane32_swap_b32 v121, v123
    s_add_u32 s73, s73, 32768
    s_nop 0
    v_permlane16_swap_b32 v120, v121
    v_permlane16_swap_b32 v122, v123
    buffer_store_dwordx4 v[120:123], v3, s[52:55], s73 offen sc1
    s_waitcnt lgkmcnt(0)
    v_dot2_f32_bf16 v44, v124, s72, v44
    v_dot2_f32_bf16 v45, v124, v124, v45
    v_dot2_f32_bf16 v44, v125, s72, v44
    v_dot2_f32_bf16 v45, v125, v125, v45
    v_dot2_f32_bf16 v44, v126, s72, v44
    v_dot2_f32_bf16 v45, v126, v126, v45
    v_dot2_f32_bf16 v44, v127, s72, v44
    v_dot2_f32_bf16 v45, v127, v127, v45
    v_permlane32_swap_b32 v124, v126
    v_permlane32_swap_b32 v125, v127
    s_add_u32 s73, s73, 32768
    s_nop 0
    v_permlane16_swap_b32 v124, v125
    v_permlane16_swap_b32 v126, v127
    buffer_store_dwordx4 v[124:127], v3, s[52:55], s73 offen sc1
    v_lshlrev_b32 v6, 3, v1
    s_lshl_b32 s75, s60, 9
    s_add_u32 s75, s75, 66560
    v_add_u32 v7, s75, v6
    v_add_u32 v6, 66560, v6
    ds_write_b64 v7, v[44:45]
    s_waitcnt lgkmcnt(0)
    s_barrier
    ds_read_b64 v[128:129], v6 offset:0
    ds_read_b64 v[130:131], v6 offset:512
    ds_read_b64 v[132:133], v6 offset:1024
    ds_read_b64 v[134:135], v6 offset:1536
    s_waitcnt lgkmcnt(0)
    v_pk_add_f32 v[128:129], v[128:129], v[130:131]
    v_pk_add_f32 v[132:133], v[132:133], v[134:135]
    v_pk_add_f32 v[128:129], v[128:129], v[132:133]
    v_mul_f32 v128, 0x3b000000, v128
    v_mul_f32 v129, 0x3b000000, v129
    v_fma_f32 v129, -v128, v128, v129
    v_max_f32 v129, 0, v129
    v_cvt_pk_bf16_f32 v130, v128, v129
    v_and_b32 v129, 0xffff0000, v130
    v_add_f32 v129, 0x3727c5ac, v129
    v_cvt_pk_bf16_f32 v129, v129, v129
    v_and_b32 v129, 0xffff0000, v129
    v_sqrt_f32 v129, v129
    v_lshlrev_b32 v128, 16, v130
    v_cvt_pk_bf16_f32 v131, v129, v129
    v_and_b32 v131, 0xffff0000, v131
    v_rcp_f32 v132, v131
    v_lshlrev_b32 v4, 3, v4
    s_lshl_b32 s75, s62, 9
    s_add_u32 s75, s75, 0xb00000
    s_cmp_eq_u32 s60, 0
    s_cselect_b32 s75, s75, 0x7ff00000
    v_mul_f32 v133, v128, v132
    buffer_store_dwordx2 v[132:133], v4, s[52:55], s75 offen sc1
    s_mov_b32 s77, 0
    s_waitcnt vmcnt(17)
L_nretry_7:
    v_readfirstlane_b32 s65, v20
    s_add_u32 s77, s77, 1
    s_nop 0
    s_cmp_lg_u32 s65, 0
    s_cbranch_scc1 L_nok_8
    s_cmp_ge_u32 s77, 20000
    s_cbranch_scc1 L_nok_8
    buffer_load_dword v20, off, s[56:59], 0 sc1
    s_waitcnt vmcnt(0)
    s_branch L_nretry_7
L_nok_8:
    s_waitcnt vmcnt(0)
    s_barrier
    s_cmp_lg_u32 s60, 0
    s_cbranch_scc1 L_noX_9
    s_lshl_b32 s73, s62, 2
    s_add_u32 s73, s73, 0xb04000
    s_mov_b32 s12, s65
    s_atomic_swap s12, s[32:33], s73
    s_add_u32 s73, s73, 128
    s_mov_b32 s13, s65
    s_atomic_swap s13, s[32:33], s73
    s_add_u32 s73, s73, 128
    s_mov_b32 s14, s65
    s_atomic_swap s14, s[32:33], s73
    s_add_u32 s73, s73, 128
    s_mov_b32 s15, s65
    s_atomic_swap s15, s[32:33], s73
    s_add_u32 s73, s73, 128
    s_mov_b32 s16, s65
    s_atomic_swap s16, s[32:33], s73
    s_add_u32 s73, s73, 128
    s_mov_b32 s17, s65
    s_atomic_swap s17, s[32:33], s73
    s_add_u32 s73, s73, 128
    s_mov_b32 s18, s65
    s_atomic_swap s18, s[32:33], s73
    s_add_u32 s73, s73, 128
    s_mov_b32 s19, s65
    s_atomic_swap s19, s[32:33], s73
L_noX_9:
    s_lshl_b32 s76, s60, 13
    s_add_u32 m0, s76, 33024
    s_add_u32 s78, s9, 0
    buffer_load_dwordx4 v10, s[44:47], s78 offen offset:0 lds
    buffer_load_dwordx4 v11, s[44:47], s78 offen offset:1024 lds
    buffer_load_dwordx4 v12, s[44:47], s78 offen offset:2048 lds
    buffer_load_dwordx4 v13, s[44:47], s78 offen offset:3072 lds
    s_lshl_b32 s76, s60, 13
    s_add_u32 m0, s76, 37120
    s_add_u32 s78, s9, 32768
    buffer_load_dwordx4 v10, s[44:47], s78 offen offset:0 lds
    buffer_load_dwordx4 v11, s[44:47], s78 offen offset:1024 lds
    buffer_load_dwordx4 v12, s[44:47], s78 offen offset:2048 lds
    buffer_load_dwordx4 v13, s[44:47], s78 offen offset:3072 lds
    s_barrier
    s_barrier
    s_barrier
    s_lshl_b32 s76, s60, 13
    s_add_u32 m0, s76, 66048
    s_add_u32 s78, s9, 65536
    buffer_load_dwordx4 v10, s[44:47], s78 offen offset:0 lds
    buffer_load_dwordx4 v11, s[44:47], s78 offen offset:1024 lds
    buffer_load_dwordx4 v12, s[44:47], s78 offen offset:2048 lds
    buffer_load_dwordx4 v13, s[44:47], s78 offen offset:3072 lds
    s_lshl_b32 s76, s60, 13
    s_add_u32 m0, s76, 70144
    s_add_u32 s78, s9, 98304
    buffer_load_dwordx4 v10, s[44:47], s78 offen offset:0 lds
    buffer_load_dwordx4 v11, s[44:47], s78 offen offset:1024 lds
    buffer_load_dwordx4 v12, s[44:47], s78 offen offset:2048 lds
    buffer_load_dwordx4 v13, s[44:47], s78 offen offset:3072 lds
    s_barrier
    s_barrier
    s_barrier
    s_lshl_b32 s76, s60, 13
    s_add_u32 m0, s76, 0
    s_add_u32 s78, s9, 131072
    buffer_load_dwordx4 v10, s[44:47], s78 offen offset:0 lds
    buffer_load_dwordx4 v11, s[44:47], s78 offen offset:1024 lds
    buffer_load_dwordx4 v12, s[44:47], s78 offen offset:2048 lds
    buffer_load_dwordx4 v13, s[44:47], s78 offen offset:3072 lds
    s_lshl_b32 s76, s60, 13
    s_add_u32 m0, s76, 4096
    s_add_u32 s78, s9, 163840
    buffer_load_dwordx4 v10, s[44:47], s78 offen offset:0 lds
    buffer_load_dwordx4 v11, s[44:47], s78 offen offset:1024 lds
    buffer_load_dwordx4 v12, s[44:47], s78 offen offset:2048 lds
    buffer_load_dwordx4 v13, s[44:47], s78 offen offset:3072 lds
    s_waitcnt vmcnt(22)
    ds_read_b64_tr_b16 v[224:225], v14 offset:33024
    ds_read_b64_tr_b16 v[226:227], v14 offset:34048
    ds_read_b64_tr_b16 v[228:229], v15 offset:33024
    ds_read_b64_tr_b16 v[230:231], v15 offset:34048
    s_waitcnt vmcnt(20)
    ds_read_b64_tr_b16 v[232:233], v14 offset:35072
    ds_read_b64_tr_b16 v[234:235], v14 offset:36096
    ds_read_b64_tr_b16 v[236:237], v15 offset:35072
    ds_read_b64_tr_b16 v[238:239], v15 offset:36096
    s_waitcnt vmcnt(18)
    ds_read_b64_tr_b16 v[240:241], v14 offset:37120
    ds_read_b64_tr_b16 v[242:243], v14 offset:38144
    ds_read_b64_tr_b16 v[244:245], v15 offset:37120
    ds_read_b64_tr_b16 v[246:247], v15 offset:38144
    s_waitcnt vmcnt(16)
    ds_read_b64_tr_b16 v[248:249], v14 offset:39168
    ds_read_b64_tr_b16 v[250:251], v14 offset:40192
    ds_read_b64_tr_b16 v[252:253], v15 offset:39168
    ds_read_b64_tr_b16 v[254:255], v15 offset:40192
    s_waitcnt lgkmcnt(0)
    s_barrier
    s_barrier
    s_barrier
    s_lshl_b32 s76, s60, 13
    s_add_u32 m0, s76, 99072
    s_add_u32 s78, s9, 196608
    buffer_load_dwordx4 v10, s[44:47], s78 offen offset:0 lds
    buffer_load_dwordx4 v11, s[44:47], s78 offen offset:1024 lds
    buffer_load_dwordx4 v12, s[44:47], s78 offen offset:2048 lds
    buffer_load_dwordx4 v13, s[44:47], s78 offen offset:3072 lds
    s_lshl_b32 s76, s60, 13
    s_add_u32 m0, s76, 103168
    s_add_u32 s78, s9, 229376
    buffer_load_dwordx4 v10, s[44:47], s78 offen offset:0 lds
    buffer_load_dwordx4 v11, s[44:47], s78 offen offset:1024 lds
    buffer_load_dwordx4 v12, s[44:47], s78 offen offset:2048 lds
    buffer_load_dwordx4 v13, s[44:47], s78 offen offset:3072 lds
    s_waitcnt vmcnt(8)
    s_branch L_JOIN
L_SWAVE:
    s_sub_u32 s62, s60, 4
    s_setprio 2
    s_mov_b32 s44, s26
    s_mov_b32 s45, s27
    s_mov_b32 s46, 0x1c0000
    s_mov_b32 s47, 0x20000
    v_min_u32 v18, 55, v1
    v_lshlrev_b32 v18, 7, v18
    s_mul_i32 s34, s2, 7168
    s_cmp_eq_u32 s62, 0
    s_cselect_b32 s34, s34, 0x7ff00000
    s_mov_b32 s56, s30
    s_mov_b32 s57, s31
    s_mov_b32 s58, 0x100
    s_mov_b32 s59, 0x20000
    s_mov_b32 s52, s32
    s_mov_b32 s53, s33
    s_mov_b32 s54, 0xb40000
    s_mov_b32 s55, 0x20000
    s_mov_b32 s36, s4
    s_mov_b32 s37, s5
    s_mov_b32 s38, 0x200000
    s_mov_b32 s39, 0x20000
    s_mov_b32 s48, s28
    s_mov_b32 s49, s29
    s_mov_b32 s50, 0x200000
    s_mov_b32 s51, 0x20000
    v_mov_b32 v22, 136944
    v_mov_b32 v23, 1
    s_mul_i32 s64, s62, 16128
    s_add_u32 s64, s64, 99072
    v_lshl_add_u32 v128, v1, 2, s64
    v_xor_b32 v129, 16, v128
    v_xor_b32 v130, 32, v128
    v_xor_b32 v131, 48, v128
    v_xor_b32 v132, 64, v128
    v_xor_b32 v133, 80, v128
    v_xor_b32 v134, 96, v128
    v_xor_b32 v135, 112, v128
    v_xor_b32 v136, 128, v128
    v_xor_b32 v137, 144, v128
    v_xor_b32 v138, 160, v128
    v_xor_b32 v139, 176, v128
    v_xor_b32 v140, 192, v128
    v_xor_b32 v141, 208, v128
    v_xor_b32 v142, 224, v128
    v_xor_b32 v143, 240, v128
    v_and_b32 v2, 15, v1
    v_lshrrev_b32 v3, 4, v1
    v_and_b32 v7, 15, v2
    v_xor_b32 v7, v7, v3
    v_lshlrev_b32 v7, 4, v7
    v_lshl_add_u32 v7, v2, 8, v7
    v_add_u32 v96, s64, v7
    v_add_u32 v97, 4096, v96
    v_bfe_u32 v4, v2, 1, 1
    v_add_u32 v4, v4, v2
    v_lshrrev_b32 v4, 1, v4
    v_add_u32 v5, 32, v4
    v_and_b32 v7, 15, v5
    v_xor_b32 v7, v7, v3
    v_lshlrev_b32 v7, 4, v7
    v_lshl_add_u32 v7, v5, 8, v7
    v_add_u32 v98, s64, v7
    v_and_b32 v4, 3, v1
    v_min_u32 v4, 2, v4
    v_bfe_u32 v5, v1, 2, 1
    v_lshl_add_u32 v5, v5, 1, v4
    v_bfe_u32 v6, v1, 3, 1
    v_mul_u32_u24 v6, 5, v6
    v_add3_u32 v5, v5, v6, 41
    v_and_b32 v7, 15, v5
    v_xor_b32 v7, v7, v3
    v_lshlrev_b32 v7, 4, v7
    v_lshl_add_u32 v7, v5, 8, v7
    v_add_u32 v99, s64, v7
    v_bfe_u32 v5, v1, 2, 2
    v_mul_u32_u24 v5, 3, v5
    v_add3_u32 v5, v5, v4, 51
    v_and_b32 v7, 15, v5
    v_xor_b32 v7, v7, v3
    v_lshlrev_b32 v7, 4, v7
    v_lshl_add_u32 v7, v5, 8, v7
    v_add_u32 v100, s64, v7
    s_and_b32 s63, s62, 1
    s_cmp_eq_u32 s63, 0
    s_cselect_b64 vcc, -1, 0
    s_nop 1
    v_cndmask_b32 v97, v98, v97, vcc
    v_cndmask_b32 v98, v99, v100, vcc
    v_mov_b32 v116, 0
    v_mov_b32 v117, 0
    v_mov_b32 v118, 0
    v_mov_b32 v119, 0
    s_lshr_b32 s75, s62, 1
    s_mul_i32 s75, s75, 4608
    s_lshl_b32 s76, s63, 8
    s_add_u32 s75, s75, s76
    s_add_u32 s75, s75, 137984
    v_lshl_add_u32 v110, v1, 4, s75
    v_lshlrev_b32 v111, 2, v1
    s_lshr_b32 s75, s62, 1
    s_mul_i32 s75, s75, 8320
    s_add_u32 s75, s75, 147200
    v_add_u32 v111, s75, v111
    s_lshl_b32 s76, s63, 9
    s_sub_u32 s76, s75, s76
    s_add_u32 s76, s76, 4088
    v_lshlrev_b32 v4, 5, v2
    v_lshl_add_u32 v108, v3, 3, v4
    v_sub_u32 v108, s76, v108
    v_add_u32 v112, 4158, v108
    s_lshl_b32 s76, s63, 6
    s_sub_u32 s76, s76, 1
    s_add_u32 s74, s75, 4144
    v_mov_b32 v5, s74
    v_cmp_eq_u32 vcc, s76, v1
    v_lshrrev_b32 v6, s63, v3
    v_lshl_add_u32 v4, v6, 9, v4
    v_cndmask_b32 v112, v112, v5, vcc
    v_and_b32 v6, s63, v3
    v_lshl_add_u32 v4, v6, 4, v4
    s_mul_i32 s76, s63, 1040
    s_add_u32 s76, s76, s75
    s_add_u32 s76, s76, 2016
    v_sub_u32 v109, s76, v4
    s_lshl_b32 s74, s63, 1
    s_sub_u32 s74, 1, s74
    s_mul_i32 s35, s74, 16128
    s_waitcnt lgkmcnt(0)
    s_lshr_b32 s74, s62, 1
    s_lshl_b32 s74, s74, 4
    s_lshr_b32 s75, s70, s74
    s_lshl_b32 s75, s75, 16
    s_lshr_b32 s71, s71, s74
    s_lshl_b32 s71, s71, 16
    v_mov_b32 v2, 0x3fb8aa3b
    v_mul_f32 v2, s75, v2
    v_exp_f32 v2, v2
    s_nop 0
    v_cvt_pk_bf16_f32 v2, v2, v2
    v_and_b32 v2, 0xffff0000, v2
    s_waitcnt vmcnt(0)
    v_mul_f32 v56, v2, v56
    v_mul_f32 v57, v2, v57
    v_mul_f32 v58, v2, v58
    v_mul_f32 v59, v2, v59
    v_mul_f32 v56, 0x3fb8aa3b, v56
    v_mul_f32 v57, 0.15915494, v57
    v_fract_f32 v3, v57
    v_exp_f32 v2, v56
    v_cos_f32 v144, v3
    v_sin_f32 v145, v3
    s_nop 0
    v_pk_mul_f32 v[144:145], v[144:145], v[2:3] op_sel_hi:[1,0]
    v_mul_f32 v2, 0x41800000, v56
    v_mul_f32 v3, 0x41800000, v57
    v_fract_f32 v3, v3
    v_exp_f32 v2, v2
    v_cos_f32 v146, v3
    v_sin_f32 v147, v3
    s_nop 0
    v_pk_mul_f32 v[146:147], v[146:147], v[2:3] op_sel_hi:[1,0]
    v_mul_f32 v2, 0x43800000, v56
    v_mul_f32 v3, 0x43800000, v57
    v_fract_f32 v3, v3
    v_exp_f32 v2, v2
    v_cos_f32 v148, v3
    v_sin_f32 v149, v3
    s_nop 0
    v_pk_mul_f32 v[148:149], v[148:149], v[2:3] op_sel_hi:[1,0]
    v_pk_mul_f32 v[152:153], v[60:61], v[58:59] op_sel_hi:[0,1]
    v_pk_fma_f32 v[152:153], v[60:61], v[58:59], v[152:153] op_sel:[1,1,0] op_sel_hi:[1,0,1] neg_lo:[0,1,0]
    v_mov_b32 v24, 0x3f80
    v_cvt_pk_bf16_f32 v25, v152, v153
    v_pk_mul_f32 v[154:155], v[152:153], v[144:145] op_sel_hi:[0,1]
    v_pk_fma_f32 v[154:155], v[152:153], v[144:145], v[154:155] op_sel:[1,1,0] op_sel_hi:[1,0,1] neg_lo:[0,1,0]
    ds_write2st64_b32 v128, v24, v25 offset0:0 offset1:16
    v_cvt_pk_bf16_f32 v26, v146, -v147
    v_cvt_pk_bf16_f32 v27, v154, v155
    v_pk_mul_f32 v[156:157], v[154:155], v[144:145] op_sel_hi:[0,1]
    v_pk_fma_f32 v[156:157], v[154:155], v[144:145], v[156:157] op_sel:[1,1,0] op_sel_hi:[1,0,1] neg_lo:[0,1,0]
    ds_write2st64_b32 v129, v26, v27 offset0:1 offset1:17
    v_mul_f32 v186, v146, v146
    v_mul_f32 v187, v146, v147
    v_fma_f32 v186, -v147, v147, v186
    v_fmac_f32 v187, v147, v146
    v_cvt_pk_bf16_f32 v28, v186, -v187
    v_cvt_pk_bf16_f32 v29, v156, v157
    v_pk_mul_f32 v[158:159], v[156:157], v[144:145] op_sel_hi:[0,1]
    v_pk_fma_f32 v[158:159], v[156:157], v[144:145], v[158:159] op_sel:[1,1,0] op_sel_hi:[1,0,1] neg_lo:[0,1,0]
    ds_write2st64_b32 v130, v28, v29 offset0:2 offset1:18
    v_pk_mul_f32 v[188:189], v[186:187], v[146:147] op_sel_hi:[0,1]
    v_pk_fma_f32 v[188:189], v[186:187], v[146:147], v[188:189] op_sel:[1,1,0] op_sel_hi:[1,0,1] neg_lo:[0,1,0]
    v_cvt_pk_bf16_f32 v30, v188, -v189
    v_cvt_pk_bf16_f32 v31, v158, v159
    v_pk_mul_f32 v[160:161], v[158:159], v[144:145] op_sel_hi:[0,1]
    v_pk_fma_f32 v[160:161], v[158:159], v[144:145], v[160:161] op_sel:[1,1,0] op_sel_hi:[1,0,1] neg_lo:[0,1,0]
    ds_write2st64_b32 v131, v30, v31 offset0:3 offset1:19
    v_pk_mul_f32 v[186:187], v[188:189], v[146:147] op_sel_hi:[0,1]
    v_pk_fma_f32 v[186:187], v[188:189], v[146:147], v[186:187] op_sel:[1,1,0] op_sel_hi:[1,0,1] neg_lo:[0,1,0]
    v_cvt_pk_bf16_f32 v32, v186, -v187
    v_cvt_pk_bf16_f32 v33, v160, v161
    v_pk_mul_f32 v[162:163], v[160:161], v[144:145] op_sel_hi:[0,1]
    v_pk_fma_f32 v[162:163], v[160:161], v[144:145], v[162:163] op_sel:[1,1,0] op_sel_hi:[1,0,1] neg_lo:[0,1,0]
    ds_write2st64_b32 v132, v32, v33 offset0:4 offset1:20
    v_pk_mul_f32 v[188:189], v[186:187], v[146:147] op_sel_hi:[0,1]
    v_pk_fma_f32 v[188:189], v[186:187], v[146:147], v[188:189] op_sel:[1,1,0] op_sel_hi:[1,0,1] neg_lo:[0,1,0]
    v_cvt_pk_bf16_f32 v34, v188, -v189
    v_cvt_pk_bf16_f32 v35, v162, v163
    v_pk_mul_f32 v[164:165], v[162:163], v[144:145] op_sel_hi:[0,1]
    v_pk_fma_f32 v[164:165], v[162:163], v[144:145], v[164:165] op_sel:[1,1,0] op_sel_hi:[1,0,1] neg_lo:[0,1,0]
    ds_write2st64_b32 v133, v34, v35 offset0:5 offset1:21
    v_pk_mul_f32 v[186:187], v[188:189], v[146:147] op_sel_hi:[0,1]
    v_pk_fma_f32 v[186:187], v[188:189], v[146:147], v[186:187] op_sel:[1,1,0] op_sel_hi:[1,0,1] neg_lo:[0,1,0]
    v_cvt_pk_bf16_f32 v36, v186, -v187
    v_cvt_pk_bf16_f32 v37, v164, v165
    v_pk_mul_f32 v[166:167], v[164:165], v[144:145] op_sel_hi:[0,1]
    v_pk_fma_f32 v[166:167], v[164:165], v[144:145], v[166:167] op_sel:[1,1,0] op_sel_hi:[1,0,1] neg_lo:[0,1,0]
    ds_write2st64_b32 v134, v36, v37 offset0:6 offset1:22
    v_pk_mul_f32 v[188:189], v[186:187], v[146:147] op_sel_hi:[0,1]
    v_pk_fma_f32 v[188:189], v[186:187], v[146:147], v[188:189] op_sel:[1,1,0] op_sel_hi:[1,0,1] neg_lo:[0,1,0]
    v_cvt_pk_bf16_f32 v38, v188, -v189
    v_cvt_pk_bf16_f32 v39, v166, v167
    s_setprio 0
    s_cmp_lg_u32 s67, 3
    s_cbranch_scc1 L_nospare_10
    s_barrier
    s_barrier
    s_barrier
L_nospare_10:
    s_barrier
    buffer_load_dword v19, v18, s[44:47], s34 offen
    v_mul_f32 v168, v166, v144
    v_mul_f32 v169, v166, v145
    v_fma_f32 v168, -v167, v145, v168
    v_fmac_f32 v169, v167, v144
    ds_write2st64_b32 v135, v38, v39 offset0:7 offset1:23
    v_mul_f32 v186, v188, v146
    v_mul_f32 v187, v188, v147
    v_fma_f32 v186, -v189, v147, v186
    v_fmac_f32 v187, v189, v146
    v_cvt_pk_bf16_f32 v40, v186, -v187
    v_cvt_pk_bf16_f32 v41, v168, v169
    v_mul_f32 v170, v168, v144
    v_mul_f32 v171, v168, v145
    v_fma_f32 v170, -v169, v145, v170
    v_fmac_f32 v171, v169, v144
    v_mul_f32 v188, v186, v146
    v_mul_f32 v189, v186, v147
    v_fma_f32 v188, -v187, v147, v188
    v_fmac_f32 v189, v187, v146
    v_cvt_pk_bf16_f32 v42, v188, -v189
    v_cvt_pk_bf16_f32 v43, v170, v171
    v_mul_f32 v172, v170, v144
    v_mul_f32 v173, v170, v145
    v_fma_f32 v172, -v171, v145, v172
    v_fmac_f32 v173, v171, v144
    v_mul_f32 v186, v188, v146
    v_mul_f32 v187, v188, v147
    v_fma_f32 v186, -v189, v147, v186
    v_fmac_f32 v187, v189, v146
    v_cvt_pk_bf16_f32 v44, v186, -v187
    v_cvt_pk_bf16_f32 v45, v172, v173
    v_mul_f32 v174, v172, v144
    v_mul_f32 v175, v172, v145
    v_fma_f32 v174, -v173, v145, v174
    v_fmac_f32 v175, v173, v144
    v_mul_f32 v188, v186, v146
    v_mul_f32 v189, v186, v147
    v_fma_f32 v188, -v187, v147, v188
    v_fmac_f32 v189, v187, v146
    v_cvt_pk_bf16_f32 v46, v188, -v189
    v_cvt_pk_bf16_f32 v47, v174, v175
    v_mul_f32 v176, v174, v144
    v_mul_f32 v177, v174, v145
    v_fma_f32 v176, -v175, v145, v176
    v_fmac_f32 v177, v175, v144
    v_mul_f32 v186, v188, v146
    v_mul_f32 v187, v188, v147
    v_fma_f32 v186, -v189, v147, v186
    v_fmac_f32 v187, v189, v146
    v_cvt_pk_bf16_f32 v48, v186, -v187
    v_cvt_pk_bf16_f32 v49, v176, v177
    v_mul_f32 v178, v176, v144
    v_mul_f32 v179, v176, v145
    v_fma_f32 v178, -v177, v145, v178
    v_fmac_f32 v179, v177, v144
    v_mul_f32 v188, v186, v146
    v_mul_f32 v189, v186, v147
    v_fma_f32 v188, -v187, v147, v188
    v_fmac_f32 v189, v187, v146
    v_cvt_pk_bf16_f32 v50, v188, -v189
    v_cvt_pk_bf16_f32 v51, v178, v179
    s_barrier
    v_mul_f32 v180, v178, v144
    v_mul_f32 v181, v178, v145
    v_fma_f32 v180, -v179, v145, v180
    v_fmac_f32 v181, v179, v144
    v_mul_f32 v186, v188, v146
    v_mul_f32 v187, v188, v147
    v_fma_f32 v186, -v189, v147, v186
    v_fmac_f32 v187, v189, v146
    v_cvt_pk_bf16_f32 v52, v186, -v187
    v_cvt_pk_bf16_f32 v53, v180, v181
    v_mul_f32 v182, v180, v144
    v_mul_f32 v183, v180, v145
    v_fma_f32 v182, -v181, v145, v182
    v_fmac_f32 v183, v181, v144
    v_mul_f32 v188, v186, v146
    v_mul_f32 v189, v186, v147
    v_fma_f32 v188, -v187, v147, v188
    v_fmac_f32 v189, v187, v146
    v_cvt_pk_bf16_f32 v54, v188, -v189
    v_cvt_pk_bf16_f32 v55, v182, v183
    v_mul_f32 v184, v182, v144
    v_mul_f32 v185, v182, v145
    v_fma_f32 v184, -v183, v145, v184
    v_fmac_f32 v185, v183, v144
    v_mul_f32 v154, v152, v148
    v_mul_f32 v155, v152, v149
    v_fma_f32 v154, -v153, v149, v154
    v_fmac_f32 v155, v153, v148
    v_cvt_pk_bf16_f32 v64, v154, v155
    v_mul_f32 v158, v156, v148
    v_mul_f32 v159, v156, v149
    v_fma_f32 v158, -v157, v149, v158
    v_fmac_f32 v159, v157, v148
    v_cvt_pk_bf16_f32 v65, v158, v159
    v_mul_f32 v162, v160, v148
    v_mul_f32 v163, v160, v149
    v_fma_f32 v162, -v161, v149, v162
    v_fmac_f32 v163, v161, v148
    v_cvt_pk_bf16_f32 v66, v162, v163
    v_mul_f32 v166, v164, v148
    v_mul_f32 v167, v164, v149
    v_fma_f32 v166, -v165, v149, v166
    v_fmac_f32 v167, v165, v148
    v_cvt_pk_bf16_f32 v67, v166, v167
    v_mul_f32 v170, v168, v148
    v_mul_f32 v171, v168, v149
    v_fma_f32 v170, -v169, v149, v170
    v_fmac_f32 v171, v169, v148
    v_cvt_pk_bf16_f32 v68, v170, v171
    v_mul_f32 v174, v172, v148
    v_mul_f32 v175, v172, v149
    v_fma_f32 v174, -v173, v149, v174
    v_fmac_f32 v175, v173, v148
    v_cvt_pk_bf16_f32 v69, v174, v175
    v_mul_f32 v178, v176, v148
    v_mul_f32 v179, v176, v149
    v_fma_f32 v178, -v177, v149, v178
    v_fmac_f32 v179, v177, v148
    v_cvt_pk_bf16_f32 v70, v178, v179
    v_mul_f32 v182, v180, v148
    v_mul_f32 v183, v180, v149
    v_fma_f32 v182, -v181, v149, v182
    v_fmac_f32 v183, v181, v148
    v_cvt_pk_bf16_f32 v71, v182, v183
    s_barrier
    v_mul_f32 v186, v184, v148
    v_mul_f32 v187, v184, v149
    v_fma_f32 v186, -v185, v149, v186
    v_fmac_f32 v187, v185, v148
    v_cvt_pk_bf16_f32 v72, v186, v187
    v_mul_f32 v152, v154, v148
    v_mul_f32 v153, v154, v149
    v_fma_f32 v152, -v155, v149, v152
    v_fmac_f32 v153, v155, v148
    v_cvt_pk_bf16_f32 v73, v152, v153
    v_mul_f32 v160, v162, v148
    v_mul_f32 v161, v162, v149
    v_fma_f32 v160, -v163, v149, v160
    v_fmac_f32 v161, v163, v148
    v_cvt_pk_bf16_f32 v74, v160, v161
    v_mul_f32 v168, v170, v148
    v_mul_f32 v169, v170, v149
    v_fma_f32 v168, -v171, v149, v168
    v_fmac_f32 v169, v171, v148
    v_cvt_pk_bf16_f32 v75, v168, v169
    v_mul_f32 v176, v178, v148
    v_mul_f32 v177, v178, v149
    v_fma_f32 v176, -v179, v149, v176
    v_fmac_f32 v177, v179, v148
    v_cvt_pk_bf16_f32 v76, v176, v177
    v_mul_f32 v184, v186, v148
    v_mul_f32 v185, v186, v149
    v_fma_f32 v184, -v187, v149, v184
    v_fmac_f32 v185, v187, v148
    v_cvt_pk_bf16_f32 v77, v184, v185
    v_mul_f32 v154, v152, v148
    v_mul_f32 v155, v152, v149
    v_fma_f32 v154, -v153, v149, v154
    v_fmac_f32 v155, v153, v148
    v_cvt_pk_bf16_f32 v78, v154, v155
    v_mul_f32 v162, v160, v148
    v_mul_f32 v163, v160, v149
    v_fma_f32 v162, -v161, v149, v162
    v_fmac_f32 v163, v161, v148
    v_cvt_pk_bf16_f32 v79, v162, v163
    v_mul_f32 v170, v168, v148
    v_mul_f32 v171, v168, v149
    v_fma_f32 v170, -v169, v149, v170
    v_fmac_f32 v171, v169, v148
    v_cvt_pk_bf16_f32 v80, v170, v171
    v_mul_f32 v178, v176, v148
    v_mul_f32 v179, v176, v149
    v_fma_f32 v178, -v177, v149, v178
    v_fmac_f32 v179, v177, v148
    v_cvt_pk_bf16_f32 v81, v178, v179
    v_mul_f32 v186, v184, v148
    v_mul_f32 v187, v184, v149
    v_fma_f32 v186, -v185, v149, v186
    v_fmac_f32 v187, v185, v148
    v_cvt_pk_bf16_f32 v82, v186, v187
    v_mul_f32 v152, v154, v148
    v_mul_f32 v153, v154, v149
    v_fma_f32 v152, -v155, v149, v152
    v_fmac_f32 v153, v155, v148
    v_cvt_pk_bf16_f32 v83, v152, v153
    s_barrier
    v_mul_f32 v168, v170, v148
    v_mul_f32 v169, v170, v149
    v_fma_f32 v168, -v171, v149, v168
    v_fmac_f32 v169, v171, v148
    v_cvt_pk_bf16_f32 v84, v168, v169
    v_mul_f32 v184, v186, v148
    v_mul_f32 v185, v186, v149
    v_fma_f32 v184, -v187, v149, v184
    v_fmac_f32 v185, v187, v148
    v_cvt_pk_bf16_f32 v85, v184, v185
    v_mul_f32 v154, v152, v148
    v_mul_f32 v155, v152, v149
    v_fma_f32 v154, -v153, v149, v154
    v_fmac_f32 v155, v153, v148
    v_cvt_pk_bf16_f32 v86, v154, v155
    v_mul_f32 v170, v168, v148
    v_mul_f32 v171, v168, v149
    v_fma_f32 v170, -v169, v149, v170
    v_fmac_f32 v171, v169, v148
    v_cvt_pk_bf16_f32 v87, v170, v171
    v_mul_f32 v186, v184, v148
    v_mul_f32 v187, v184, v149
    v_fma_f32 v186, -v185, v149, v186
    v_fmac_f32 v187, v185, v148
    v_cvt_pk_bf16_f32 v88, v186, v187
    v_mul_f32 v152, v154, v148
    v_mul_f32 v153, v154, v149
    v_fma_f32 v152, -v155, v149, v152
    v_fmac_f32 v153, v155, v148
    v_cvt_pk_bf16_f32 v89, v152, v153
    v_mul_f32 v168, v170, v148
    v_mul_f32 v169, v170, v149
    v_fma_f32 v168, -v171, v149, v168
    v_fmac_f32 v169, v171, v148
    v_cvt_pk_bf16_f32 v90, v168, v169
    v_mul_f32 v184, v186, v148
    v_mul_f32 v185, v186, v149
    v_fma_f32 v184, -v187, v149, v184
    v_fmac_f32 v185, v187, v148
    v_cvt_pk_bf16_f32 v91, v184, v185
    v_mul_f32 v154, v152, v148
    v_mul_f32 v155, v152, v149
    v_fma_f32 v154, -v153, v149, v154
    v_fmac_f32 v155, v153, v148
    v_cvt_pk_bf16_f32 v92, v154, v155
    v_mul_f32 v170, v168, v148
    v_mul_f32 v171, v168, v149
    v_fma_f32 v170, -v169, v149, v170
    v_fmac_f32 v171, v169, v148
    v_cvt_pk_bf16_f32 v93, v170, v171
    v_mul_f32 v186, v184, v148
    v_mul_f32 v187, v184, v149
    v_fma_f32 v186, -v185, v149, v186
    v_fmac_f32 v187, v185, v148
    v_cvt_pk_bf16_f32 v94, v186, v187
    s_barrier
    s_setprio 3
    ds_write2st64_b32 v136, v40, v41 offset0:8 offset1:24
    ds_write2st64_b32 v137, v42, v43 offset0:9 offset1:25
    ds_write2st64_b32 v138, v44, v45 offset0:10 offset1:26
    ds_write2st64_b32 v139, v46, v47 offset0:11 offset1:27
    ds_write2st64_b32 v140, v48, v49 offset0:12 offset1:28
    ds_write2st64_b32 v141, v50, v51 offset0:13 offset1:29
    ds_write2st64_b32 v142, v52, v53 offset0:14 offset1:30
    ds_write2st64_b32 v143, v54, v55 offset0:15 offset1:31
    ds_write_b32 v128, v64 offset:8192
    ds_write_b32 v129, v65 offset:8448
    ds_write_b32 v130, v66 offset:8704
    ds_write_b32 v131, v67 offset:8960
    ds_write_b32 v132, v68 offset:9216
    ds_write_b32 v133, v69 offset:9472
    ds_write_b32 v134, v70 offset:9728
    ds_write_b32 v135, v71 offset:9984
    ds_write_b32 v136, v72 offset:10240
    ds_write_b32 v137, v73 offset:10496
    ds_write_b32 v138, v74 offset:10752
    ds_write_b32 v139, v75 offset:11008
    ds_write_b32 v140, v76 offset:11264
    ds_write_b32 v141, v77 offset:11520
    ds_write_b32 v142, v78 offset:11776
    ds_write_b32 v143, v79 offset:12032
    ds_write_b32 v128, v80 offset:12288
    ds_write_b32 v129, v81 offset:12544
    ds_write_b32 v130, v82 offset:12800
    ds_write_b32 v131, v83 offset:13056
    ds_write_b32 v132, v84 offset:13312
    ds_write_b32 v133, v85 offset:13568
    ds_write_b32 v134, v86 offset:13824
    ds_write_b32 v135, v87 offset:14080
    ds_write_b32 v136, v88 offset:14336
    ds_write_b32 v137, v89 offset:14592
    ds_write_b32 v138, v90 offset:14848
    ds_write_b32 v139, v91 offset:15104
    ds_write_b32 v140, v92 offset:15360
    ds_write_b32 v141, v93 offset:15616
    ds_write_b32 v142, v94 offset:15872
    s_waitcnt lgkmcnt(0)
    s_barrier
    ds_read_b128 v[196:199], v96
    ds_read_b128 v[200:203], v97
    ds_read_b128 v[204:207], v98
    v_xor_b32 v96, 64, v96
    ds_read_b128 v[208:211], v96
    v_xor_b32 v97, 64, v97
    ds_read_b128 v[212:215], v97
    v_xor_b32 v98, 64, v98
    ds_read_b128 v[216:219], v98
    v_xor_b32 v96, 192, v96
    ds_read_b128 v[220:223], v96
    v_xor_b32 v97, 192, v97
    ds_read_b128 v[224:227], v97
    v_xor_b32 v98, 192, v98
    ds_read_b128 v[228:231], v98
    v_xor_b32 v96, 64, v96
    ds_read_b128 v[232:235], v96
    v_xor_b32 v97, 64, v97
    ds_read_b128 v[236:239], v97
    v_xor_b32 v98, 64, v98
    ds_read_b128 v[240:243], v98
    v_add_u32 v96, s35, v96
    v_xor_b32 v96, 192, v96
    ds_read_b128 v[244:247], v96
    v_add_u32 v97, s35, v97
    v_xor_b32 v97, 192, v97
    ds_read_b128 v[248:251], v97
    v_add_u32 v98, s35, v98
    v_xor_b32 v98, 192, v98
    ds_read_b128 v[252:255], v98
    s_waitcnt lgkmcnt(13)
    v_mfma_f32_16x16x32_bf16 v[64:67], v[200:203], v[196:199], 0
    s_waitcnt lgkmcnt(12)
    v_mfma_f32_16x16x32_bf16 v[68:71], v[204:207], v[196:199], 0
    v_xor_b32 v96, 64, v96
    ds_read_b128 v[196:199], v96
    v_xor_b32 v97, 64, v97
    ds_read_b128 v[200:203], v97
    v_xor_b32 v98, 64, v98
    ds_read_b128 v[204:207], v98
    s_waitcnt lgkmcnt(13)
    v_mfma_f32_16x16x32_bf16 v[64:67], v[212:215], v[208:211], v[64:67]
    s_waitcnt lgkmcnt(12)
    v_mfma_f32_16x16x32_bf16 v[68:71], v[216:219], v[208:211], v[68:71]
    v_xor_b32 v96, 192, v96
    ds_read_b128 v[208:211], v96
    v_xor_b32 v97, 192, v97
    ds_read_b128 v[212:215], v97
    v_xor_b32 v98, 192, v98
    ds_read_b128 v[216:219], v98
    s_waitcnt lgkmcnt(13)
    v_mfma_f32_16x16x32_bf16 v[64:67], v[224:227], v[220:223], v[64:67]
    s_waitcnt lgkmcnt(12)
    v_mfma_f32_16x16x32_bf16 v[68:71], v[228:231], v[220:223], v[68:71]
    v_xor_b32 v96, 64, v96
    ds_read_b128 v[220:223], v96
    v_xor_b32 v97, 64, v97
    ds_read_b128 v[224:227], v97
    v_xor_b32 v98, 64, v98
    ds_read_b128 v[228:231], v98
    s_waitcnt lgkmcnt(13)
    v_mfma_f32_16x16x32_bf16 v[64:67], v[236:239], v[232:235], v[64:67]
    s_waitcnt lgkmcnt(12)
    v_mfma_f32_16x16x32_bf16 v[68:71], v[240:243], v[232:235], v[68:71]
    s_waitcnt lgkmcnt(10)
    v_mfma_f32_16x16x32_bf16 v[64:67], v[248:251], v[244:247], v[64:67]
    s_waitcnt lgkmcnt(9)
    v_mfma_f32_16x16x32_bf16 v[68:71], v[252:255], v[244:247], v[68:71]
    s_waitcnt lgkmcnt(7)
    v_mfma_f32_16x16x32_bf16 v[64:67], v[200:203], v[196:199], v[64:67]
    s_waitcnt lgkmcnt(6)
    v_mfma_f32_16x16x32_bf16 v[68:71], v[204:207], v[196:199], v[68:71]
    s_waitcnt lgkmcnt(4)
    v_mfma_f32_16x16x32_bf16 v[64:67], v[212:215], v[208:211], v[64:67]
    s_waitcnt lgkmcnt(3)
    v_mfma_f32_16x16x32_bf16 v[68:71], v[216:219], v[208:211], v[68:71]
    s_waitcnt lgkmcnt(1)
    v_mfma_f32_16x16x32_bf16 v[64:67], v[224:227], v[220:223], v[64:67]
    s_waitcnt lgkmcnt(0)
    v_mfma_f32_16x16x32_bf16 v[68:71], v[228:231], v[220:223], v[68:71]
    s_barrier
    s_nop 3
    s_mov_b64 exec, 0x1ff
    ds_write_b32 v111, v116 offset:4096
    s_cmp_lg_u32 s63, 0
    s_cbranch_scc1 L_kz_11
    ds_write_b32 v111, v116 offset:8252
L_kz_11:
    s_mov_b64 exec, -1
    v_cvt_pk_bf16_f32 v212, v67, v66
    v_cvt_pk_bf16_f32 v213, v65, v64
    v_cvt_pk_bf16_f32 v214, v66, v65
    ds_write_b64 v108, v[212:213]
    ds_write_b32 v108, v214 offset:4160
    ds_write_b16_d16_hi v108, v213 offset:4164
    ds_write_b16 v112, v212
    s_cmp_lg_u32 s63, 0
    s_cbranch_scc1 L_kfh_12
    v_cvt_pk_bf16_f32 v216, v70, v70
    v_cvt_pk_bf16_f32 v217, v70, v70
    v_cvt_pk_bf16_f32 v218, v69, v69
    v_cvt_pk_bf16_f32 v219, v69, v69
    v_cvt_pk_bf16_f32 v220, v69, v69
    v_cvt_pk_bf16_f32 v221, v69, v68
    v_cvt_pk_bf16_f32 v222, v68, v68
    v_cvt_pk_bf16_f32 v223, v68, v68
    v_cvt_pk_bf16_f32 v224, v70, v70
    v_cvt_pk_bf16_f32 v225, v70, v69
    v_cvt_pk_bf16_f32 v226, v69, v69
    v_cvt_pk_bf16_f32 v227, v69, v69
    v_cvt_pk_bf16_f32 v228, v69, v69
    v_cvt_pk_bf16_f32 v229, v68, v68
    v_cvt_pk_bf16_f32 v230, v68, v68
    v_cvt_pk_bf16_f32 v231, v68, v68
    ds_write_b128 v109, v[216:219] offset:0
    ds_write_b128 v109, v[220:223] offset:16
    ds_write_b128 v109, v[224:227] offset:4160
    ds_write_b128 v109, v[228:231] offset:4176
    s_branch L_kfj_13
L_kfh_12:
    v_cvt_pk_bf16_f32 v216, v70, v70
    v_cvt_pk_bf16_f32 v217, v69, v69
    v_cvt_pk_bf16_f32 v218, v69, v68
    v_cvt_pk_bf16_f32 v219, v68, v68
    v_cvt_pk_bf16_f32 v220, v70, v69
    v_cvt_pk_bf16_f32 v221, v69, v69
    v_cvt_pk_bf16_f32 v222, v68, v68
    v_cvt_pk_bf16_f32 v223, v68, v68
    ds_write_b128 v109, v[216:219] offset:0
    ds_write_b128 v109, v[220:223] offset:4160
L_kfj_13:
    s_mov_b64 exec, 0xffff
    ds_write_b128 v110, v[116:119]
    s_mov_b64 exec, 1
    ds_write_b128 v22, v[116:119]
    s_mov_b64 exec, -1
    buffer_load_dword v20, off, s[56:59], 0 sc1
    s_waitcnt lgkmcnt(0)
    s_barrier
    s_setprio 3
    v_and_b32 v2, 7, v1
    v_lshlrev_b32 v2, 2, v2
    s_and_b32 s73, s2, 7
    s_lshl_b32 s73, s73, 2
    s_add_u32 s73, s73, s62
    s_lshl_b32 s73, s73, 5
    s_add_u32 s75, s73, 0xb04000
    buffer_load_dword v21, v2, s[52:55], s75 offen sc1
    s_lshr_b32 s68, s62, 1
    s_and_b32 s69, s62, 1
    v_and_b32 v4, 15, v1
    v_lshrrev_b32 v5, 4, v1
    v_and_b32 v6, 1, v1
    v_mul_u32_u24 v6, 4158, v6
    v_lshl_add_u32 v6, v4, 1, v6
    v_lshlrev_b32 v7, 4, v5
    v_sub_u32 v6, v7, v6
    s_mul_i32 s73, s68, 8320
    s_lshl_b32 s74, s69, 8
    s_sub_u32 s73, s73, s74
    s_add_u32 s73, s73, 154844
    v_add_u32 v96, s73, v6
    v_subrev_u32 v97, 1024, v96
    v_subrev_u32 v98, 2048, v96
    v_subrev_u32 v99, 3072, v96
    v_lshl_add_u32 v6, v4, 5, v7
    s_mul_i32 s73, s68, 4608
    s_sub_u32 s74, s73, s74
    s_add_u32 s74, s74, 138400
    v_add_u32 v100, s74, v6
    s_lshl_b32 s74, s62, 12
    s_add_u32 s74, s74, 33024
    v_lshl_add_u32 v101, v1, 4, s74
    s_xor_b32 s74, s62, 1
    s_lshl_b32 s74, s74, 12
    s_add_u32 s74, s74, 33024
    v_lshl_add_u32 v102, v1, 4, s74
    v_lshlrev_b32 v103, 5, v4
    v_lshl_add_u32 v103, v5, 3, v103
    s_lshl_b32 s74, s69, 11
    s_add_u32 s73, s73, s74
    s_add_u32 s73, s73, 138496
    v_add_u32 v104, s73, v103
    v_lshl_add_u32 v105, v1, 4, s73
    s_lshl_b32 s73, s68, 2
    s_add_u32 s73, s73, 136948
    v_mov_b32 v106, s73
    v_lshrrev_b32 v6, 3, v1
    v_and_b32 v7, 7, v1
    v_lshlrev_b32 v7, 4, v7
    v_lshl_add_u32 v103, v6, 13, v7
    v_add_u32 v107, 65536, v103
    s_lshl_b32 s73, s2, 1
    s_add_u32 s73, s73, s68
    s_lshr_b32 s70, s73, 6
    s_lshl_b32 s70, s70, 1
    s_add_u32 s70, s70, s69
    s_lshl_b32 s70, s70, 10
    s_and_b32 s74, s73, 63
    s_add_u32 s70, s70, s74
    s_lshl_b32 s70, s70, 7
    s_add_u32 s70, s70, 0x900000
    s_lshl_b32 s74, s69, 9
    s_add_u32 s73, s73, s74
    s_lshr_b32 s74, s73, 4
    s_lshl_b32 s74, s74, 7
    s_and_b32 s73, s73, 15
    s_lshl_b32 s73, s73, 2
    s_add_u32 s73, s73, s74
    s_add_u32 s8, s73, 0xb06000
    v_lshrrev_b32 v4, 3, v1
    v_and_b32 v5, 7, v1
    s_lshl2_add_u32 s74, s66, s62
    s_lshl_b32 s79, s74, 7
    s_add_u32 s79, s79, 0xb00000
    v_lshlrev_b32 v37, 3, v4
    v_lshlrev_b32 v6, 10, v4
    v_lshl_add_u32 v36, v5, 4, v6
    s_lshl_b32 s74, s74, 14
    s_lshl_b32 s73, s67, 7
    s_add_u32 s9, s74, s73
    s_add_u32 s10, s9, 8192
    s_waitcnt vmcnt(0)
    s_mov_b32 s77, 0
L_nretry_14:
    v_readfirstlane_b32 s65, v20
    s_add_u32 s77, s77, 1
    s_nop 0
    s_cmp_lg_u32 s65, 0
    s_cbranch_scc1 L_nok_15
    s_cmp_ge_u32 s77, 20000
    s_cbranch_scc1 L_nok_15
    buffer_load_dword v20, off, s[56:59], 0 sc1
    s_waitcnt vmcnt(0)
    s_branch L_nretry_14
L_nok_15:
    v_cmp_ne_u32 vcc, s65, v21
    s_mov_b32 s63, 1
    s_nop 0
    s_cmp_eq_u64 vcc, 0
    s_cbranch_scc1 L_fxfast_16
    buffer_load_dword v21, v2, s[52:55], s75 offen sc1
    s_waitcnt vmcnt(0)
    v_cmp_ne_u32 vcc, s65, v21
    s_nop 1
    s_cmp_eq_u64 vcc, 0
    s_cbranch_scc1 L_fxfast_16
    s_mov_b32 s63, 0
    s_barrier
    s_mov_b32 s77, 0
    buffer_load_dword v21, v2, s[52:55], s75 offen sc1
    s_waitcnt vmcnt(0)
L_retry_17:
    v_cmp_ne_u32 vcc, s65, v21
    s_add_u32 s77, s77, 1
    s_nop 0
    s_cmp_eq_u64 vcc, 0
    s_cbranch_scc1 L_ok_18
    s_cmp_ge_u32 s77, 20000
    s_cbranch_scc1 L_ok_18
    s_sleep 12
    buffer_load_dword v21, v2, s[52:55], s75 offen sc1
    s_waitcnt vmcnt(0)
    s_branch L_retry_17
L_ok_18:
L_fxfast_16:
    v_lshlrev_b32 v2, 4, v1
    v_lshlrev_b32 v4, 5, v1
    s_lshl_b32 s73, s2, 13
    s_lshl_b32 s74, s62, 11
    s_add_u32 s73, s73, s74
    s_add_u32 s73, s73, 0x700000
    s_lshl_b32 s74, s62, 12
    s_add_u32 s74, s74, 0xb00000
    buffer_load_dwordx4 v[128:131], v2, s[52:55], s73 offen offset:0 sc1
    buffer_load_dwordx4 v[136:139], v4, s[52:55], s74 offen offset:0 sc1
    buffer_load_dwordx4 v[140:143], v4, s[52:55], s74 offen offset:16 sc1
    buffer_load_dwordx4 v[132:135], v2, s[52:55], s73 offen offset:1024 sc1
    buffer_load_dwordx4 v[144:147], v4, s[52:55], s74 offen offset:2048 sc1
    buffer_load_dwordx4 v[148:151], v4, s[52:55], s74 offen offset:2064 sc1
    buffer_load_dwordx4 v[24:27], v36, s[36:39], s9 offen
    buffer_load_dwordx4 v[28:31], v36, s[36:39], s10 offen
    s_lshl_b32 s74, s62, 10
    s_add_u32 s74, s74, 138496
    v_lshl_add_u32 v3, v1, 3, s74
    s_cmp_eq_u32 s63, 0
    s_cbranch_scc1 L_nb_19
    s_barrier
L_nb_19:
    s_waitcnt vmcnt(5)
    v_lshlrev_b32 v152, 16, v128
    v_and_b32 v153, 0xffff0000, v128
    v_fma_f32 v152, v152, v136, -v137
    v_fma_f32 v153, v153, v136, -v137
    v_lshlrev_b32 v154, 16, v129
    v_and_b32 v155, 0xffff0000, v129
    v_fma_f32 v154, v154, v138, -v139
    v_fma_f32 v155, v155, v138, -v139
    v_lshlrev_b32 v156, 16, v130
    v_and_b32 v157, 0xffff0000, v130
    v_fma_f32 v156, v156, v140, -v141
    v_fma_f32 v157, v157, v140, -v141
    v_lshlrev_b32 v158, 16, v131
    v_and_b32 v159, 0xffff0000, v131
    v_fma_f32 v158, v158, v142, -v143
    v_fma_f32 v159, v159, v142, -v143
    v_cvt_pk_bf16_f32 v128, v152, v154
    v_cvt_pk_bf16_f32 v129, v156, v158
    v_cvt_pk_bf16_f32 v130, v153, v155
    v_cvt_pk_bf16_f32 v131, v157, v159
    ds_write_b64 v3, v[128:129] offset:0
    ds_write_b64 v3, v[130:131] offset:4608
    s_waitcnt vmcnt(2)
    v_lshlrev_b32 v152, 16, v132
    v_and_b32 v153, 0xffff0000, v132
    v_fma_f32 v152, v152, v144, -v145
    v_fma_f32 v153, v153, v144, -v145
    v_lshlrev_b32 v154, 16, v133
    v_and_b32 v155, 0xffff0000, v133
    v_fma_f32 v154, v154, v146, -v147
    v_fma_f32 v155, v155, v146, -v147
    v_lshlrev_b32 v156, 16, v134
    v_and_b32 v157, 0xffff0000, v134
    v_fma_f32 v156, v156, v148, -v149
    v_fma_f32 v157, v157, v148, -v149
    v_lshlrev_b32 v158, 16, v135
    v_and_b32 v159, 0xffff0000, v135
    v_fma_f32 v158, v158, v150, -v151
    v_fma_f32 v159, v159, v150, -v151
    v_cvt_pk_bf16_f32 v132, v152, v154
    v_cvt_pk_bf16_f32 v133, v156, v158
    v_cvt_pk_bf16_f32 v134, v153, v155
    v_cvt_pk_bf16_f32 v135, v157, v159
    ds_write_b64 v3, v[132:133] offset:512
    ds_write_b64 v3, v[134:135] offset:5120
    s_mov_b64 exec, 1
    ds_add_u32 v22, v23
    s_mov_b64 exec, -1
    v_mov_b32 v64, 0
    v_mov_b32 v65, 0
    v_mov_b32 v66, 0
    v_mov_b32 v67, 0
    v_mov_b32 v68, 0
    v_mov_b32 v69, 0
    v_mov_b32 v70, 0
    v_mov_b32 v71, 0
    v_mov_b32 v72, 0
    v_mov_b32 v73, 0
    v_mov_b32 v74, 0
    v_mov_b32 v75, 0
    v_mov_b32 v76, 0
    v_mov_b32 v77, 0
    v_mov_b32 v78, 0
    v_mov_b32 v79, 0
    v_mov_b32 v80, 0
    v_mov_b32 v81, 0
    v_mov_b32 v82, 0
    v_mov_b32 v83, 0
    v_mov_b32 v84, 0
    v_mov_b32 v85, 0
    v_mov_b32 v86, 0
    v_mov_b32 v87, 0
    v_mov_b32 v88, 0
    v_mov_b32 v89, 0
    v_mov_b32 v90, 0
    v_mov_b32 v91, 0
    v_mov_b32 v92, 0
    v_mov_b32 v93, 0
    v_mov_b32 v94, 0
    v_mov_b32 v95, 0
    s_mov_b32 s77, 0
L_sb_20:
    ds_read_b32 v21, v22 offset:0
    ds_read2_b32 v[128:129], v96 offset0:144 offset1:145
    ds_read2_b32 v[130:131], v96 offset0:146 offset1:147
    ds_read_b128 v[188:191], v100 offset:3648
    ds_read_b128 v[184:187], v100 offset:3136
    ds_read_b128 v[180:183], v100 offset:2624
    ds_read_b128 v[176:179], v100 offset:2112
    ds_read_b128 v[172:175], v100 offset:1600
    ds_read_b128 v[168:171], v100 offset:1088
    ds_read_b128 v[164:167], v100 offset:576
    ds_read_b128 v[160:163], v100 offset:64
    ds_read2_b32 v[132:133], v96 offset0:16 offset1:17
    ds_read2_b32 v[134:135], v96 offset0:18 offset1:19
    ds_read2_b32 v[136:137], v97 offset0:144 offset1:145
    ds_read2_b32 v[138:139], v97 offset0:146 offset1:147
    ds_read2_b32 v[140:141], v97 offset0:16 offset1:17
    ds_read2_b32 v[142:143], v97 offset0:18 offset1:19
    ds_read2_b32 v[144:145], v98 offset0:144 offset1:145
    ds_read2_b32 v[146:147], v98 offset0:146 offset1:147
    ds_read2_b32 v[148:149], v98 offset0:16 offset1:17
    ds_read2_b32 v[150:151], v98 offset0:18 offset1:19
    ds_read2_b32 v[152:153], v99 offset0:144 offset1:145
    ds_read2_b32 v[154:155], v99 offset0:146 offset1:147
    ds_read2_b32 v[156:157], v99 offset0:16 offset1:17
    ds_read2_b32 v[158:159], v99 offset0:18 offset1:19
    s_add_u32 s77, s77, 1
    s_waitcnt lgkmcnt(0)
    v_readfirstlane_b32 s100, v21
    s_cmp_ge_u32 s77, 200000
    s_cbranch_scc1 L_sbok_21
    s_cmp_lt_u32 s100, 4
    s_cbranch_scc1 L_sb_20
L_sbok_21:
    s_setprio 3
    s_mov_b32 s73, 0
L_cloop_22:
    s_waitcnt lgkmcnt(15)
    v_mfma_f32_16x16x32_bf16 v[92:95], v[128:131], v[188:191], v[92:95]
    v_mfma_f32_16x16x32_bf16 v[88:91], v[128:131], v[184:187], v[88:91]
    v_mfma_f32_16x16x32_bf16 v[84:87], v[128:131], v[180:183], v[84:87]
    v_mfma_f32_16x16x32_bf16 v[80:83], v[128:131], v[176:179], v[80:83]
    v_mfma_f32_16x16x32_bf16 v[76:79], v[128:131], v[172:175], v[76:79]
    ds_read2_b32 v[192:193], v96 offset0:128 offset1:129
    v_mfma_f32_16x16x32_bf16 v[72:75], v[128:131], v[168:171], v[72:75]
    ds_read2_b32 v[194:195], v96 offset0:130 offset1:131
    v_mfma_f32_16x16x32_bf16 v[68:71], v[128:131], v[164:167], v[68:71]
    ds_read_b128 v[252:255], v100 offset:3584
    s_waitcnt lgkmcnt(15)
    v_mfma_f32_16x16x32_bf16 v[64:67], v[128:131], v[160:163], v[64:67]
    ds_read_b128 v[248:251], v100 offset:3072
    v_mfma_f32_16x16x32_bf16 v[92:95], v[132:135], v[184:187], v[92:95]
    ds_read_b128 v[244:247], v100 offset:2560
    v_mfma_f32_16x16x32_bf16 v[88:91], v[132:135], v[180:183], v[88:91]
    ds_read_b128 v[240:243], v100 offset:2048
    v_mfma_f32_16x16x32_bf16 v[84:87], v[132:135], v[176:179], v[84:87]
    ds_read_b128 v[236:239], v100 offset:1536
    v_mfma_f32_16x16x32_bf16 v[80:83], v[132:135], v[172:175], v[80:83]
    ds_read_b128 v[232:235], v100 offset:1024
    v_mfma_f32_16x16x32_bf16 v[76:79], v[132:135], v[168:171], v[76:79]
    ds_read_b128 v[228:231], v100 offset:512
    v_mfma_f32_16x16x32_bf16 v[72:75], v[132:135], v[164:167], v[72:75]
    ds_read_b128 v[224:227], v100 offset:0
    v_mfma_f32_16x16x32_bf16 v[68:71], v[132:135], v[160:163], v[68:71]
    ds_read2_b32 v[196:197], v96 offset0:0 offset1:1
    s_waitcnt lgkmcnt(15)
    v_mfma_f32_16x16x32_bf16 v[92:95], v[136:139], v[180:183], v[92:95]
    ds_read2_b32 v[198:199], v96 offset0:2 offset1:3
    v_mfma_f32_16x16x32_bf16 v[88:91], v[136:139], v[176:179], v[88:91]
    ds_read2_b32 v[200:201], v97 offset0:128 offset1:129
    v_mfma_f32_16x16x32_bf16 v[84:87], v[136:139], v[172:175], v[84:87]
    ds_read2_b32 v[202:203], v97 offset0:130 offset1:131
    v_mfma_f32_16x16x32_bf16 v[80:83], v[136:139], v[168:171], v[80:83]
    ds_read2_b32 v[204:205], v97 offset0:0 offset1:1
    v_mfma_f32_16x16x32_bf16 v[76:79], v[136:139], v[164:167], v[76:79]
    ds_read2_b32 v[206:207], v97 offset0:2 offset1:3
    v_mfma_f32_16x16x32_bf16 v[72:75], v[136:139], v[160:163], v[72:75]
    ds_read2_b32 v[208:209], v98 offset0:128 offset1:129
    v_mfma_f32_16x16x32_bf16 v[92:95], v[140:143], v[176:179], v[92:95]
    ds_read2_b32 v[210:211], v98 offset0:130 offset1:131
    v_mfma_f32_16x16x32_bf16 v[88:91], v[140:143], v[172:175], v[88:91]
    ds_read2_b32 v[212:213], v98 offset0:0 offset1:1
    v_mfma_f32_16x16x32_bf16 v[84:87], v[140:143], v[168:171], v[84:87]
    ds_read2_b32 v[214:215], v98 offset0:2 offset1:3
    v_mfma_f32_16x16x32_bf16 v[80:83], v[140:143], v[164:167], v[80:83]
    ds_read2_b32 v[216:217], v99 offset0:128 offset1:129
    v_mfma_f32_16x16x32_bf16 v[76:79], v[140:143], v[160:163], v[76:79]
    ds_read2_b32 v[218:219], v99 offset0:130 offset1:131
    v_mfma_f32_16x16x32_bf16 v[92:95], v[144:147], v[172:175], v[92:95]
    ds_read2_b32 v[220:221], v99 offset0:0 offset1:1
    v_mfma_f32_16x16x32_bf16 v[88:91], v[144:147], v[168:171], v[88:91]
    ds_read2_b32 v[222:223], v99 offset0:2 offset1:3
    v_mfma_f32_16x16x32_bf16 v[84:87], v[144:147], v[164:167], v[84:87]
    v_mfma_f32_16x16x32_bf16 v[80:83], v[144:147], v[160:163], v[80:83]
    v_mfma_f32_16x16x32_bf16 v[92:95], v[148:151], v[168:171], v[92:95]
    v_mfma_f32_16x16x32_bf16 v[88:91], v[148:151], v[164:167], v[88:91]
    v_mfma_f32_16x16x32_bf16 v[84:87], v[148:151], v[160:163], v[84:87]
    s_waitcnt lgkmcnt(15)
    v_mfma_f32_16x16x32_bf16 v[92:95], v[152:155], v[164:167], v[92:95]
    v_mfma_f32_16x16x32_bf16 v[88:91], v[152:155], v[160:163], v[88:91]
    v_mfma_f32_16x16x32_bf16 v[92:95], v[156:159], v[160:163], v[92:95]
    v_subrev_u32 v96, 128, v96
    v_subrev_u32 v97, 128, v97
    v_subrev_u32 v98, 128, v98
    v_subrev_u32 v99, 128, v99
    v_subrev_u32 v100, 128, v100
    v_mfma_f32_16x16x32_bf16 v[92:95], v[192:195], v[252:255], v[92:95]
    v_mfma_f32_16x16x32_bf16 v[88:91], v[192:195], v[248:251], v[88:91]
    v_mfma_f32_16x16x32_bf16 v[84:87], v[192:195], v[244:247], v[84:87]
    v_mfma_f32_16x16x32_bf16 v[80:83], v[192:195], v[240:243], v[80:83]
    v_mfma_f32_16x16x32_bf16 v[76:79], v[192:195], v[236:239], v[76:79]
    ds_read2_b32 v[128:129], v96 offset0:144 offset1:145
    v_mfma_f32_16x16x32_bf16 v[72:75], v[192:195], v[232:235], v[72:75]
    ds_read2_b32 v[130:131], v96 offset0:146 offset1:147
    v_mfma_f32_16x16x32_bf16 v[68:71], v[192:195], v[228:231], v[68:71]
    ds_read_b128 v[188:191], v100 offset:3648
    s_waitcnt lgkmcnt(15)
    v_mfma_f32_16x16x32_bf16 v[64:67], v[192:195], v[224:227], v[64:67]
    ds_read_b128 v[184:187], v100 offset:3136
    v_mfma_f32_16x16x32_bf16 v[92:95], v[196:199], v[248:251], v[92:95]
    ds_read_b128 v[180:183], v100 offset:2624
    v_mfma_f32_16x16x32_bf16 v[88:91], v[196:199], v[244:247], v[88:91]
    ds_read_b128 v[176:179], v100 offset:2112
    v_mfma_f32_16x16x32_bf16 v[84:87], v[196:199], v[240:243], v[84:87]
    ds_read_b128 v[172:175], v100 offset:1600
    v_mfma_f32_16x16x32_bf16 v[80:83], v[196:199], v[236:239], v[80:83]
    ds_read_b128 v[168:171], v100 offset:1088
    v_mfma_f32_16x16x32_bf16 v[76:79], v[196:199], v[232:235], v[76:79]
    ds_read_b128 v[164:167], v100 offset:576
    v_mfma_f32_16x16x32_bf16 v[72:75], v[196:199], v[228:231], v[72:75]
    ds_read_b128 v[160:163], v100 offset:64
    v_mfma_f32_16x16x32_bf16 v[68:71], v[196:199], v[224:227], v[68:71]
    ds_read2_b32 v[132:133], v96 offset0:16 offset1:17
    s_waitcnt lgkmcnt(15)
    v_mfma_f32_16x16x32_bf16 v[92:95], v[200:203], v[244:247], v[92:95]
    ds_read2_b32 v[134:135], v96 offset0:18 offset1:19
    v_mfma_f32_16x16x32_bf16 v[88:91], v[200:203], v[240:243], v[88:91]
    ds_read2_b32 v[136:137], v97 offset0:144 offset1:145
    v_mfma_f32_16x16x32_bf16 v[84:87], v[200:203], v[236:239], v[84:87]
    ds_read2_b32 v[138:139], v97 offset0:146 offset1:147
    v_mfma_f32_16x16x32_bf16 v[80:83], v[200:203], v[232:235], v[80:83]
    ds_read2_b32 v[140:141], v97 offset0:16 offset1:17
    v_mfma_f32_16x16x32_bf16 v[76:79], v[200:203], v[228:231], v[76:79]
    ds_read2_b32 v[142:143], v97 offset0:18 offset1:19
    v_mfma_f32_16x16x32_bf16 v[72:75], v[200:203], v[224:227], v[72:75]
    ds_read2_b32 v[144:145], v98 offset0:144 offset1:145
    v_mfma_f32_16x16x32_bf16 v[92:95], v[204:207], v[240:243], v[92:95]
    ds_read2_b32 v[146:147], v98 offset0:146 offset1:147
    v_mfma_f32_16x16x32_bf16 v[88:91], v[204:207], v[236:239], v[88:91]
    ds_read2_b32 v[148:149], v98 offset0:16 offset1:17
    v_mfma_f32_16x16x32_bf16 v[84:87], v[204:207], v[232:235], v[84:87]
    ds_read2_b32 v[150:151], v98 offset0:18 offset1:19
    v_mfma_f32_16x16x32_bf16 v[80:83], v[204:207], v[228:231], v[80:83]
    ds_read2_b32 v[152:153], v99 offset0:144 offset1:145
    v_mfma_f32_16x16x32_bf16 v[76:79], v[204:207], v[224:227], v[76:79]
    ds_read2_b32 v[154:155], v99 offset0:146 offset1:147
    v_mfma_f32_16x16x32_bf16 v[92:95], v[208:211], v[236:239], v[92:95]
    ds_read2_b32 v[156:157], v99 offset0:16 offset1:17
    v_mfma_f32_16x16x32_bf16 v[88:91], v[208:211], v[232:235], v[88:91]
    ds_read2_b32 v[158:159], v99 offset0:18 offset1:19
    v_mfma_f32_16x16x32_bf16 v[84:87], v[208:211], v[228:231], v[84:87]
    v_mfma_f32_16x16x32_bf16 v[80:83], v[208:211], v[224:227], v[80:83]
    v_mfma_f32_16x16x32_bf16 v[92:95], v[212:215], v[232:235], v[92:95]
    v_mfma_f32_16x16x32_bf16 v[88:91], v[212:215], v[228:231], v[88:91]
    v_mfma_f32_16x16x32_bf16 v[84:87], v[212:215], v[224:227], v[84:87]
    s_waitcnt lgkmcnt(15)
    v_mfma_f32_16x16x32_bf16 v[92:95], v[216:219], v[228:231], v[92:95]
    v_mfma_f32_16x16x32_bf16 v[88:91], v[216:219], v[224:227], v[88:91]
    v_mfma_f32_16x16x32_bf16 v[92:95], v[220:223], v[224:227], v[92:95]
    s_add_u32 s73, s73, 1
    s_cmp_lt_u32 s73, 2
    s_cbranch_scc1 L_cloop_22
    s_setprio 3
    ds_read_b64 v[192:193], v104 offset:0
    ds_read_b64 v[194:195], v104 offset:512
    ds_read_b64 v[196:197], v104 offset:1024
    ds_read_b64 v[198:199], v104 offset:1536
    s_cmp_lg_u32 s69, 0
    s_cbranch_scc1 L_yhi_23
    ds_write_b128 v101, v[80:83] offset:0
    ds_write_b128 v101, v[84:87] offset:1024
    ds_write_b128 v101, v[88:91] offset:2048
    ds_write_b128 v101, v[92:95] offset:3072
    s_branch L_yj_24
L_yhi_23:
    ds_write_b128 v101, v[64:67] offset:0
    ds_write_b128 v101, v[68:71] offset:1024
    ds_write_b128 v101, v[72:75] offset:2048
    ds_write_b128 v101, v[76:79] offset:3072
    s_nop 0
    v_mov_b32 v64, v80
    v_mov_b32 v65, v81
    v_mov_b32 v66, v82
    v_mov_b32 v67, v83
    v_mov_b32 v68, v84
    v_mov_b32 v69, v85
    v_mov_b32 v70, v86
    v_mov_b32 v71, v87
    v_mov_b32 v72, v88
    v_mov_b32 v73, v89
    v_mov_b32 v74, v90
    v_mov_b32 v75, v91
    v_mov_b32 v76, v92
    v_mov_b32 v77, v93
    v_mov_b32 v78, v94
    v_mov_b32 v79, v95
L_yj_24:
    s_mov_b64 exec, 1
    ds_add_u32 v106, v23
    s_mov_b64 exec, -1
    s_waitcnt lgkmcnt(5)
    v_lshlrev_b32 v200, 16, v192
    v_and_b32 v201, 0xffff0000, v192
    v_lshlrev_b32 v202, 16, v193
    v_and_b32 v203, 0xffff0000, v193
    v_fmac_f32 v64, s71, v200
    v_fmac_f32 v65, s71, v201
    v_fmac_f32 v66, s71, v202
    v_fmac_f32 v67, s71, v203
    v_lshlrev_b32 v200, 16, v194
    v_and_b32 v201, 0xffff0000, v194
    v_lshlrev_b32 v202, 16, v195
    v_and_b32 v203, 0xffff0000, v195
    v_fmac_f32 v68, s71, v200
    v_fmac_f32 v69, s71, v201
    v_fmac_f32 v70, s71, v202
    v_fmac_f32 v71, s71, v203
    v_lshlrev_b32 v200, 16, v196
    v_and_b32 v201, 0xffff0000, v196
    v_lshlrev_b32 v202, 16, v197
    v_and_b32 v203, 0xffff0000, v197
    v_fmac_f32 v72, s71, v200
    v_fmac_f32 v73, s71, v201
    v_fmac_f32 v74, s71, v202
    v_fmac_f32 v75, s71, v203
    v_lshlrev_b32 v200, 16, v198
    v_and_b32 v201, 0xffff0000, v198
    v_lshlrev_b32 v202, 16, v199
    v_and_b32 v203, 0xffff0000, v199
    v_fmac_f32 v76, s71, v200
    v_fmac_f32 v77, s71, v201
    v_fmac_f32 v78, s71, v202
    v_fmac_f32 v79, s71, v203
    s_mov_b32 s77, 0
L_sb_25:
    ds_read_b32 v21, v106 offset:0
    ds_read_b128 v[128:131], v102 offset:0
    ds_read_b128 v[132:135], v102 offset:1024
    ds_read_b128 v[136:139], v102 offset:2048
    ds_read_b128 v[140:143], v102 offset:3072
    s_add_u32 s77, s77, 1
    s_waitcnt lgkmcnt(0)
    v_readfirstlane_b32 s100, v21
    s_cmp_ge_u32 s77, 200000
    s_cbranch_scc1 L_sbok_26
    s_cmp_lt_u32 s100, 2
    s_cbranch_scc1 L_sb_25
L_sbok_26:
    v_add_f32 v64, v64, v128
    v_add_f32 v65, v65, v129
    v_add_f32 v66, v66, v130
    v_add_f32 v67, v67, v131
    v_cvt_pk_bf16_f32 v204, v64, v65
    v_cvt_pk_bf16_f32 v205, v66, v67
    ds_write_b64 v104, v[204:205] offset:0
    v_add_f32 v68, v68, v132
    v_add_f32 v69, v69, v133
    v_add_f32 v70, v70, v134
    v_add_f32 v71, v71, v135
    v_cvt_pk_bf16_f32 v206, v68, v69
    v_cvt_pk_bf16_f32 v207, v70, v71
    ds_write_b64 v104, v[206:207] offset:512
    v_add_f32 v72, v72, v136
    v_add_f32 v73, v73, v137
    v_add_f32 v74, v74, v138
    v_add_f32 v75, v75, v139
    v_cvt_pk_bf16_f32 v208, v72, v73
    v_cvt_pk_bf16_f32 v209, v74, v75
    ds_write_b64 v104, v[208:209] offset:1024
    v_add_f32 v76, v76, v140
    v_add_f32 v77, v77, v141
    v_add_f32 v78, v78, v142
    v_add_f32 v79, v79, v143
    v_cvt_pk_bf16_f32 v210, v76, v77
    v_cvt_pk_bf16_f32 v211, v78, v79
    ds_write_b64 v104, v[210:211] offset:1536
    ds_read_b128 v[64:67], v105 offset:0
    ds_read_b128 v[68:71], v105 offset:1024
    s_waitcnt lgkmcnt(1)
    buffer_store_dwordx4 v[64:67], v103, s[52:55], s70 offen sc1
    s_waitcnt lgkmcnt(0)
    buffer_store_dwordx4 v[68:71], v107, s[52:55], s70 offen sc1
    v_and_b32 v2, 15, v1
    v_lshrrev_b32 v3, 4, v1
    buffer_load_dword v32, v37, s[52:55], s79 offen offset:0 sc1
    buffer_load_dword v34, v37, s[52:55], s79 offen offset:64 sc1
    s_waitcnt vmcnt(2)
    s_mov_b32 s3, s65
    s_atomic_swap s3, s[32:33], s8
    s_lshr_b32 s76, s66, 4
    s_lshl_b32 s76, s76, 3
    s_add_u32 s76, s76, s67
    s_lshl_b32 s76, s76, 2
    s_add_u32 s76, s76, s62
    s_lshl_b32 s76, s76, 7
    s_add_u32 s76, s76, 0xb06000
    v_lshlrev_b32 v4, 2, v2
    v_lshrrev_b32 v5, 3, v1
    v_and_b32 v6, 7, v1
    v_lshlrev_b32 v6, 1, v6
    v_xor_b32 v6, v6, v5
    v_lshlrev_b32 v6, 4, v6
    v_lshl_add_u32 v6, v5, 8, v6
    s_and_b32 s73, s62, 1
    s_lshl_b32 s73, s73, 12
    s_cmp_ge_u32 s62, 2
    s_cselect_b32 s74, 66048, 0
    s_add_u32 s73, s73, s74
    v_add_u32 v144, s73, v6
    v_xor_b32 v145, 16, v144
    s_mul_i32 s73, s62, 2304
    s_add_u32 s73, s73, 137984
    v_lshl_add_u32 v146, v1, 4, s73
    v_lshl_add_u32 v147, v1, 2, s73
    s_lshl_b32 s73, s62, 12
    s_add_u32 s73, s73, 33024
    v_mul_u32_u24 v5, 144, v2
    v_lshlrev_b32 v6, 4, v3
    v_add3_u32 v151, v5, v6, s73
    v_lshrrev_b32 v5, 3, v1
    v_mul_u32_u24 v5, 144, v5
    v_and_b32 v6, 7, v1
    v_lshlrev_b32 v6, 4, v6
    v_add3_u32 v152, v5, v6, s73
    v_bfe_u32 v5, v1, 2, 2
    v_lshl_add_u32 v5, v3, 3, v5
    v_mul_u32_u24 v5, 144, v5
    v_and_b32 v6, 3, v1
    v_lshl_add_u32 v5, v6, 3, v5
    s_lshl_b32 s73, s62, 5
    s_add_u32 s73, s73, 49408
    v_add_u32 v148, s73, v5
    v_lshrrev_b32 v5, 3, v1
    v_and_b32 v6, 7, v1
    v_lshlrev_b32 v6, 4, v6
    v_lshlrev_b32 v149, 4, v1
    v_mul_u32_u24 v5, 144, v5
    s_mul_i32 s73, s62, 2304
    s_add_u32 s73, s73, 49408
    v_add3_u32 v150, v5, v6, s73
    s_lshl_b32 s73, s67, 5
    s_add_u32 s73, s73, s66
    s_lshl_b32 s73, s73, 2
    s_add_u32 s73, s73, s62
    s_lshl_b32 s73, s73, 11
    s_add_u32 s69, s73, 0x900000
    s_waitcnt vmcnt(0)
    v_lshlrev_b32 v160, 16, v24
    v_and_b32 v161, 0xffff0000, v24
    v_lshlrev_b32 v162, 16, v25
    v_and_b32 v163, 0xffff0000, v25
    v_lshlrev_b32 v164, 16, v26
    v_and_b32 v165, 0xffff0000, v26
    v_lshlrev_b32 v166, 16, v27
    v_and_b32 v167, 0xffff0000, v27
    v_lshlrev_b32 v168, 16, v28
    v_and_b32 v169, 0xffff0000, v28
    v_lshlrev_b32 v170, 16, v29
    v_and_b32 v171, 0xffff0000, v29
    v_lshlrev_b32 v172, 16, v30
    v_and_b32 v173, 0xffff0000, v30
    v_lshlrev_b32 v174, 16, v31
    v_and_b32 v175, 0xffff0000, v31
    s_mov_b32 s77, 0
L_sb_27:
    ds_read_b32 v21, v22 offset:12
    s_add_u32 s77, s77, 1
    s_waitcnt lgkmcnt(0)
    v_readfirstlane_b32 s100, v21
    s_cmp_ge_u32 s77, 200000
    s_cbranch_scc1 L_sbok_28
    s_cmp_ge_u32 s100, 1
    s_cbranch_scc1 L_sbok_28
    s_sleep 2
    s_branch L_sb_27
L_sbok_28:
    s_mov_b32 s77, 0
    s_load_dwordx16 s[12:27], s[32:33], s76 glc
L_sretry_29:
    s_waitcnt lgkmcnt(0)
    s_xor_b32 s12, s12, s65
    s_xor_b32 s13, s13, s65
    s_xor_b32 s14, s14, s65
    s_xor_b32 s15, s15, s65
    s_xor_b32 s16, s16, s65
    s_xor_b32 s17, s17, s65
    s_xor_b32 s18, s18, s65
    s_xor_b32 s19, s19, s65
    s_xor_b32 s20, s20, s65
    s_xor_b32 s21, s21, s65
    s_xor_b32 s22, s22, s65
    s_xor_b32 s23, s23, s65
    s_xor_b32 s24, s24, s65
    s_xor_b32 s25, s25, s65
    s_xor_b32 s26, s26, s65
    s_xor_b32 s27, s27, s65
    s_or_b32 s12, s12, s13
    s_or_b32 s12, s12, s14
    s_or_b32 s12, s12, s15
    s_or_b32 s12, s12, s16
    s_or_b32 s12, s12, s17
    s_or_b32 s12, s12, s18
    s_or_b32 s12, s12, s19
    s_or_b32 s12, s12, s20
    s_or_b32 s12, s12, s21
    s_or_b32 s12, s12, s22
    s_or_b32 s12, s12, s23
    s_or_b32 s12, s12, s24
    s_or_b32 s12, s12, s25
    s_or_b32 s12, s12, s26
    s_or_b32 s12, s12, s27
    s_cbranch_scc0 L_sok_30
    s_add_u32 s77, s77, 1
    s_cmp_ge_u32 s77, 40000
    s_cbranch_scc1 L_sok_30
    s_sleep 4
    s_load_dwordx16 s[12:27], s[32:33], s76 glc
    s_branch L_sretry_29
L_sok_30:
    buffer_load_dwordx4 v[136:139], v149, s[52:55], s69 offen sc1
    buffer_load_dwordx4 v[140:143], v149, s[52:55], s69 offen offset:1024 sc1
    s_waitcnt vmcnt(0)
    ds_write_b128 v150, v[136:139]
    ds_write_b128 v150, v[140:143] offset:1152
    s_mov_b64 exec, 1
    ds_add_u32 v22, v23
    s_mov_b64 exec, -1
    s_mov_b32 s77, 0
L_sb_31:
    ds_read_b32 v21, v22 offset:0
    ds_read_b64_tr_b16 v[184:185], v148 offset:0
    ds_read_b64_tr_b16 v[186:187], v148 offset:576
    ds_read_b64_tr_b16 v[188:189], v148 offset:4608
    ds_read_b64_tr_b16 v[190:191], v148 offset:5184
    s_add_u32 s77, s77, 1
    s_waitcnt lgkmcnt(0)
    v_readfirstlane_b32 s100, v21
    s_cmp_ge_u32 s77, 200000
    s_cbranch_scc1 L_sbok_32
    s_cmp_lt_u32 s100, 8
    s_cbranch_scc1 L_sb_31
L_sbok_32:
    ds_write_b128 v151, v[184:187] offset:0
    ds_write_b128 v151, v[188:191] offset:64
    ds_read_b128 v[140:143], v152 offset:1152
    ds_read_b128 v[136:139], v152 offset:0
    s_waitcnt lgkmcnt(1)
    v_lshlrev_b32 v176, 16, v140
    v_and_b32 v177, 0xffff0000, v140
    v_pk_add_f32 v[168:169], v[168:169], v[176:177]
    v_lshlrev_b32 v176, 16, v141
    v_and_b32 v177, 0xffff0000, v141
    v_pk_add_f32 v[170:171], v[170:171], v[176:177]
    v_lshlrev_b32 v176, 16, v142
    v_and_b32 v177, 0xffff0000, v142
    v_pk_add_f32 v[172:173], v[172:173], v[176:177]
    v_lshlrev_b32 v176, 16, v143
    v_and_b32 v177, 0xffff0000, v143
    v_pk_add_f32 v[174:175], v[174:175], v[176:177]
    ds_write_b128 v146, v[168:171] offset:0
    ds_write_b128 v146, v[172:175] offset:1024
    ds_write_b32 v147, v34 offset:2048
    s_waitcnt lgkmcnt(3)
    v_lshlrev_b32 v176, 16, v136
    v_and_b32 v177, 0xffff0000, v136
    v_pk_add_f32 v[160:161], v[160:161], v[176:177]
    v_lshlrev_b32 v176, 16, v137
    v_and_b32 v177, 0xffff0000, v137
    v_pk_add_f32 v[162:163], v[162:163], v[176:177]
    v_lshlrev_b32 v176, 16, v138
    v_and_b32 v177, 0xffff0000, v138
    v_pk_add_f32 v[164:165], v[164:165], v[176:177]
    v_lshlrev_b32 v176, 16, v139
    v_and_b32 v177, 0xffff0000, v139
    v_pk_add_f32 v[166:167], v[166:167], v[176:177]
    s_waitcnt lgkmcnt(0)
    s_barrier
    ds_read_b128 v[64:67], v144 offset:0
    ds_read_b128 v[68:71], v145 offset:0
    ds_read_b128 v[72:75], v144 offset:8192
    ds_read_b128 v[76:79], v145 offset:8192
    ds_read_b128 v[80:83], v144 offset:16384
    ds_read_b128 v[84:87], v145 offset:16384
    ds_read_b128 v[88:91], v144 offset:24576
    ds_read_b128 v[92:95], v145 offset:24576
    s_waitcnt lgkmcnt(4)
    v_pk_add_f32 v[64:65], v[64:65], v[72:73]
    v_pk_add_f32 v[66:67], v[66:67], v[74:75]
    v_pk_add_f32 v[68:69], v[68:69], v[76:77]
    v_pk_add_f32 v[70:71], v[70:71], v[78:79]
    s_waitcnt lgkmcnt(2)
    v_pk_add_f32 v[64:65], v[64:65], v[80:81]
    v_pk_add_f32 v[66:67], v[66:67], v[82:83]
    v_pk_add_f32 v[68:69], v[68:69], v[84:85]
    v_pk_add_f32 v[70:71], v[70:71], v[86:87]
    s_waitcnt lgkmcnt(0)
    v_pk_add_f32 v[64:65], v[64:65], v[88:89]
    v_pk_add_f32 v[66:67], v[66:67], v[90:91]
    v_pk_add_f32 v[68:69], v[68:69], v[92:93]
    v_pk_add_f32 v[70:71], v[70:71], v[94:95]
    v_pk_fma_f32 v[160:161], v[64:65], v[32:33], v[160:161] op_sel_hi:[1,0,1]
    v_pk_fma_f32 v[162:163], v[66:67], v[32:33], v[162:163] op_sel_hi:[1,0,1]
    v_pk_fma_f32 v[164:165], v[68:69], v[32:33], v[164:165] op_sel_hi:[1,0,1]
    v_pk_fma_f32 v[166:167], v[70:71], v[32:33], v[166:167] op_sel_hi:[1,0,1]
    v_cvt_pk_bf16_f32 v72, v160, v161
    v_cvt_pk_bf16_f32 v73, v162, v163
    v_cvt_pk_bf16_f32 v74, v164, v165
    v_cvt_pk_bf16_f32 v75, v166, v167
    buffer_store_dwordx4 v[72:75], v36, s[48:51], s9 offen sc1
L_END:
    s_endpgm
L_CODE_END:
.section .rodata,"a"
.p2align 6
.amdhsa_kernel parallel_sum__ssm_conv_s4__dense_activation_relu__prompt_kernel
  .amdhsa_next_free_vgpr 256
  .amdhsa_next_free_sgpr 102
  .amdhsa_accum_offset 256
  .amdhsa_group_segment_fixed_size 0
  .amdhsa_kernarg_size 120
  .amdhsa_user_sgpr_count 2
  .amdhsa_user_sgpr_kernarg_segment_ptr 1
  .amdhsa_system_sgpr_workgroup_id_x 1
  .amdhsa_float_denorm_mode_32 3
.end_amdhsa_kernel
```
